```python
import torch

def _softmax(x, axis=-1):
    return torch.softmax(x, dim=axis)
def _gelu(x):
    return torch.nn.functional.gelu(x, approximate="tanh")
def _silu(x):
    return torch.nn.functional.silu(x)
def _sigmoid(x):
    return torch.sigmoid(x)
def _layernorm(x, axis=-1, eps=1e-5):
    m = x.mean(dim=axis, keepdim=True)
    v = x.var(dim=axis, keepdim=True, unbiased=False)
    return (x - m) / torch.sqrt(v + eps)
def _scatter_add(tgt, idx, src, axis=0):
    return tgt.clone().index_add_(axis, idx, src)
def _segment_sum(src, seg, n):
    out = torch.zeros((n,) + src.shape[1:], dtype=src.dtype)
    return out.index_add_(0, seg, src)
def _pad(x, pw):
    flat = tuple(v for pair in reversed(pw) for v in pair)
    return torch.nn.functional.pad(x, flat)

kernel_name = 'recurrent_scan__gqa_block_cached__dense_activation_gelu__decode'

def setup_inputs():

    _w = (lambda a: (lambda t: t.to(torch.bfloat16) if t.is_floating_point() else t)(torch.as_tensor(a)))
    def _A_setup():
        B, Sq, D = 8, 1, 448
        Hq, Hkv, Sk, Dh = 16, 8, 8192, 256
        assert Hq % Hkv == 0, (Hq, Hkv)
        return {
            "x": _w((lambda *s: torch.randn(*s, dtype=torch.bfloat16) * 0.05)(B, Sq, D)),
            "k_cache": _w((lambda *s: torch.randn(*s, dtype=torch.bfloat16) * 3.2)(B, Hkv, Sk, Dh)),
            "v_cache": _w((lambda *s: torch.randn(*s, dtype=torch.bfloat16) * 3.2)(B, Hkv, Sk, Dh)),
            "wq": _w((lambda *s: torch.randn(*s, dtype=torch.bfloat16) * 3.2)(D, Hq * Dh) * (D ** -0.5)),
            "wo": _w((lambda *s: torch.randn(*s, dtype=torch.bfloat16) * 3.2)(Hq * Dh, D) * ((Hq * Dh) ** -0.5)),
        }
    _A_in = _A_setup()

    def _B_setup():
        B, S, D, F = 8, 1, 448, 1792
        return {
            "x": _w((lambda *s: torch.randn(*s, dtype=torch.bfloat16) * 0.05)(B, S, D)),
            "w1": _w((lambda *s: torch.randn(*s, dtype=torch.bfloat16) * 3.2)(D, F) * (D ** -0.5)),
            "b1": _w((lambda *s: torch.randn(*s, dtype=torch.bfloat16) * 3.2)(F) * 0.01),
            "w2": _w((lambda *s: torch.randn(*s, dtype=torch.bfloat16) * 0.8)(F, D) * (F ** -0.5)),
            "b2": _w((lambda *s: torch.randn(*s, dtype=torch.bfloat16) * 0.8)(D) * 0.01),
        }
    _B_in = _B_setup()

    return {
        "A_x": _A_in["x"],
        "A_k_cache": _A_in["k_cache"],
        "A_v_cache": _A_in["v_cache"],
        "A_wq": _A_in["wq"],
        "A_wo": _A_in["wo"],
        "B_x": _B_in["x"],
        "B_w1": _B_in["w1"],
        "B_b1": _B_in["b1"],
        "B_w2": _B_in["w2"],
        "B_b2": _B_in["b2"],
    }

def reference(A_x, A_k_cache, A_v_cache, A_wq, A_wo, B_x, B_w1, B_b1, B_w2, B_b2):
    def _A_ref(x, k_cache, v_cache, wq, wo):
        B, Sq, D = x.shape
        Hq, Dh = 16, 256
        Hkv = k_cache.shape[1]
        rep = Hq // Hkv
        q = (lambda x, *d: x.permute(*d))((x @ wq).reshape(B, Sq, Hq, Dh), 0, 2, 1, 3)
        k = (lambda x, n, axis: torch.repeat_interleave(x, n, dim=axis))(k_cache, rep, axis=1)
        v = (lambda x, n, axis: torch.repeat_interleave(x, n, dim=axis))(v_cache, rep, axis=1)
        scores = torch.einsum("bhqd,bhkd->bhqk", q, k) * (Dh ** -0.5)
        p = _softmax(scores, axis=-1)
        o = torch.einsum("bhqk,bhkd->bhqd", p, v)
        return (lambda x, *d: x.permute(*d))(o, 0, 2, 1, 3).reshape(B, Sq, Hq * Dh) @ wo

    def _B_ref(x, w1, b1, w2, b2):
        h = torch.einsum("bsd,df->bsf", x, w1) + b1
        h = _gelu(h)
        return torch.einsum("bsf,fd->bsd", h, w2) + b2

    x = A_x
    xn = _layernorm(x, axis=-1)
    s = _A_ref(xn, A_k_cache, A_v_cache, A_wq, A_wo)
    g = _silu(_B_ref(xn, B_w1, B_b1, B_w2, B_b2))
    return x + s * g
```

```asm
; @launch kernel=recurrent_scan__gqa_block_cached__dense_activation_gelu__decode_kernel grid=(256,1,1) block=(256,1,1) lds=163840
; @launch kernel=proj_kernel grid=(184,1,1) block=(256,1,1) lds=37376
; @launch kernel=fin_kernel grid=(56,1,1) block=(256,1,1) lds=2048
.amdgcn_target "amdgcn-amd-amdhsa--gfx950"
.text
.globl recurrent_scan__gqa_block_cached__dense_activation_gelu__decode_kernel
.type recurrent_scan__gqa_block_cached__dense_activation_gelu__decode_kernel,@function
.globl proj_kernel
.type proj_kernel,@function
.globl fin_kernel
.type fin_kernel,@function
    .p2align 8
recurrent_scan__gqa_block_cached__dense_activation_gelu__decode_kernel:
    s_cmp_ge_u32 s2, 256
    s_cbranch_scc1 LA_done
    s_load_dwordx16 s[36:51], s[0:1], 0
    s_load_dwordx4 s[52:55], s[0:1], 88
    v_lshrrev_b32 v2, 6, v0
    v_and_b32 v1, 63, v0
    s_nop 0
    v_readfirstlane_b32 s3, v2
    s_and_b32 s58, s2, 7
    s_lshr_b32 s59, s2, 3
    s_lshl_b32 s59, s59, 1
    s_lshr_b32 s63, s3, 1
    s_add_u32 s59, s59, s63
    s_and_b32 s60, s3, 1
    s_lshl_b32 s57, s59, 1
    s_add_u32 s57, s57, s60
    s_lshl_b32 s56, s57, 21
    s_lshl_b32 s57, s57, 8
    s_add_u32 s57, s57, 1310720
    s_lshl_b32 s63, s58, 14
    s_add_u32 s61, s56, s63
    s_lshl_b32 s62, s3, 15
    s_add_u32 s62, s62, 32768
    v_lshrrev_b32 v2, 5, v1
    v_and_b32 v3, 31, v1
    v_lshlrev_b32 v23, 1, v2
    v_xor_b32 v3, v3, v23
    v_lshlrev_b32 v3, 4, v3
    v_lshl_add_u32 v4, v2, 9, v3
    v_xor_b32 v5, 64, v4
    v_xor_b32 v6, 128, v4
    v_xor_b32 v7, 192, v4
    v_lshlrev_b32 v2, 4, v1
    s_mov_b32 s66, 8192
    s_cmp_ge_u32 s2, 128
    s_cselect_b32 s66, 3584, s66
    s_cselect_b32 s67, 128, 0
    s_sub_u32 s67, s2, s67
    s_lshl_b32 s68, s67, 6
    v_lshrrev_b32 v3, 2, v1
    v_mul_lo_u32 v3, v3, s66
    v_and_b32 v28, 3, v1
    v_lshl_add_u32 v3, v28, 4, v3
    s_mul_i32 s69, s3, 112
    s_mul_i32 s69, s69, s66
    s_add_u32 s69, s69, s68
    s_lshl_b32 s70, s66, 4
    s_mul_i32 s71, s3, 7168
    v_mov_b32 v29, 0x40000000
    v_cmp_gt_u32 vcc, 56, v1
    s_nop 1
    v_cndmask_b32 v29, v29, v2, vcc
    s_waitcnt lgkmcnt(0)
    s_mov_b32 s8, s38
    s_mov_b32 s9, s39
    s_mov_b32 s10, 0x10000000
    s_mov_b32 s11, 0x20000
    s_mov_b32 s12, s40
    s_mov_b32 s13, s41
    s_mov_b32 s14, 0x10000000
    s_mov_b32 s15, 0x20000
    s_mov_b32 s28, s54
    s_mov_b32 s29, s55
    s_mov_b32 s30, 6291456
    s_mov_b32 s31, 0x20000
    s_mov_b32 s32, s52
    s_mov_b32 s33, s53
    s_mov_b32 s34, 256
    s_mov_b32 s35, 0x20000
    s_mov_b32 s24, s50
    s_mov_b32 s25, s51
    s_mov_b32 s26, 3584
    s_mov_b32 s27, 0x20000
    s_mov_b32 s18, 3670016
    s_cmp_ge_u32 s2, 128
    s_cselect_b32 s16, s48, s42
    s_cselect_b32 s17, s49, s43
    s_cselect_b32 s18, 1605632, s18
    s_mov_b32 s19, 0x20000
    s_mul_i32 s63, s3, 1792
    s_add_u32 s20, s36, s63
    s_addc_u32 s21, s37, 0
    s_mov_b32 s22, 1792
    s_mov_b32 s23, 0x20000
    s_cmp_ge_u32 s2, 184
    s_cbranch_scc1 LA_noP
    buffer_load_dwordx4 v[112:115], v29, s[20:23], 0 offen
    buffer_load_dwordx4 v[116:119], v29, s[20:23], 0 offen offset:896
    s_add_u32 m0, s71, 0
    s_nop 0
    buffer_load_dwordx4 v3, s[16:19], s69 offen nt lds
    s_add_u32 s69, s69, s70
    s_add_u32 m0, s71, 1024
    s_nop 0
    buffer_load_dwordx4 v3, s[16:19], s69 offen nt lds
    s_add_u32 s69, s69, s70
    s_add_u32 m0, s71, 2048
    s_nop 0
    buffer_load_dwordx4 v3, s[16:19], s69 offen nt lds
    s_add_u32 s69, s69, s70
    s_add_u32 m0, s71, 3072
    s_nop 0
    buffer_load_dwordx4 v3, s[16:19], s69 offen nt lds
    s_add_u32 s69, s69, s70
    s_add_u32 m0, s71, 4096
    s_nop 0
    buffer_load_dwordx4 v3, s[16:19], s69 offen nt lds
    s_add_u32 s69, s69, s70
    s_add_u32 m0, s71, 5120
    s_nop 0
    buffer_load_dwordx4 v3, s[16:19], s69 offen nt lds
    s_add_u32 s69, s69, s70
    s_add_u32 m0, s71, 6144
    s_nop 0
    buffer_load_dwordx4 v3, s[16:19], s69 offen nt lds
    s_add_u32 s69, s69, s70
    s_cmp_eq_u32 s3, 0
    s_cbranch_scc1 LA_w0a
    s_add_u32 m0, s62, 0
    s_add_u32 s63, s61, 0
    buffer_load_dwordx4 v4, s[8:11], s63 offen offset:0 nt lds
    buffer_load_dwordx4 v5, s[8:11], s63 offen offset:1024 nt lds
    buffer_load_dwordx4 v6, s[8:11], s63 offen offset:2048 nt lds
    buffer_load_dwordx4 v7, s[8:11], s63 offen offset:3072 nt lds
    s_add_u32 m0, s62, 4096
    s_add_u32 s63, s61, 4096
    buffer_load_dwordx4 v4, s[8:11], s63 offen offset:0 nt lds
    buffer_load_dwordx4 v5, s[8:11], s63 offen offset:1024 nt lds
    buffer_load_dwordx4 v6, s[8:11], s63 offen offset:2048 nt lds
    buffer_load_dwordx4 v7, s[8:11], s63 offen offset:3072 nt lds
    s_waitcnt vmcnt(15)
    s_branch LA_ln
LA_w0a:
    v_lshrrev_b32 v30, 4, v1
    v_lshlrev_b32 v30, 3, v30
    buffer_load_dwordx2 v[24:25], v30, s[24:27], s68 offen
    buffer_load_dwordx2 v[26:27], v30, s[24:27], s68 offen offset:32
    s_waitcnt vmcnt(9)
LA_ln:
    v_lshlrev_b32 v96, 16, v112
    v_and_b32 v97, 0xffff0000, v112
    v_lshlrev_b32 v98, 16, v113
    v_and_b32 v99, 0xffff0000, v113
    v_lshlrev_b32 v100, 16, v114
    v_and_b32 v101, 0xffff0000, v114
    v_lshlrev_b32 v102, 16, v115
    v_and_b32 v103, 0xffff0000, v115
    v_add_f32 v120, v96, v97
    v_add_f32 v121, v98, v99
    v_add_f32 v122, v100, v101
    v_add_f32 v123, v102, v103
    v_add_f32 v120, v120, v121
    v_add_f32 v122, v122, v123
    v_add_f32 v120, v120, v122
    s_nop 1
    v_add_f32 v120, v120, v120 quad_perm:[1,0,3,2]
    s_nop 1
    v_add_f32 v120, v120, v120 quad_perm:[2,3,0,1]
    s_nop 1
    v_add_f32 v120, v120, v120 row_half_mirror
    s_nop 1
    v_add_f32 v120, v120, v120 row_mirror
    v_mov_b32 v121, v120
    s_nop 1
    v_permlane16_swap_b32 v120, v121
    v_add_f32 v120, v120, v121
    v_mov_b32 v121, v120
    s_nop 1
    v_permlane32_swap_b32 v120, v121
    v_add_f32 v120, v120, v121
    v_mul_f32 v120, 0x3b124925, v120
    v_mov_b32 v122, 0
    v_sub_f32 v123, v96, v120
    v_fmac_f32 v122, v123, v123
    v_sub_f32 v123, v97, v120
    v_fmac_f32 v122, v123, v123
    v_sub_f32 v123, v98, v120
    v_fmac_f32 v122, v123, v123
    v_sub_f32 v123, v99, v120
    v_fmac_f32 v122, v123, v123
    v_sub_f32 v123, v100, v120
    v_fmac_f32 v122, v123, v123
    v_sub_f32 v123, v101, v120
    v_fmac_f32 v122, v123, v123
    v_sub_f32 v123, v102, v120
    v_fmac_f32 v122, v123, v123
    v_sub_f32 v123, v103, v120
    v_fmac_f32 v122, v123, v123
    v_cndmask_b32 v122, 0, v122, vcc
    s_nop 1
    v_add_f32 v122, v122, v122 quad_perm:[1,0,3,2]
    s_nop 1
    v_add_f32 v122, v122, v122 quad_perm:[2,3,0,1]
    s_nop 1
    v_add_f32 v122, v122, v122 row_half_mirror
    s_nop 1
    v_add_f32 v122, v122, v122 row_mirror
    v_mov_b32 v121, v122
    s_nop 1
    v_permlane16_swap_b32 v122, v121
    v_add_f32 v122, v122, v121
    v_mov_b32 v121, v122
    s_nop 1
    v_permlane32_swap_b32 v122, v121
    v_add_f32 v122, v122, v121
    v_mul_f32 v122, 0x3b124925, v122
    v_cvt_pk_bf16_f32 v120, v120, v120
    v_lshlrev_b32 v120, 16, v120
    v_cvt_pk_bf16_f32 v122, v122, v122
    v_lshlrev_b32 v122, 16, v122
    v_add_f32 v122, 0x3727c5ac, v122
    v_cvt_pk_bf16_f32 v122, v122, v122
    v_lshlrev_b32 v122, 16, v122
    v_sqrt_f32 v122, v122
    s_nop 0
    v_cvt_pk_bf16_f32 v122, v122, v122
    v_lshlrev_b32 v122, 16, v122
    v_rcp_f32 v123, v122
    v_sub_f32 v96, v96, v120
    v_cvt_pk_bf16_f32 v96, v96, v96
    v_lshlrev_b32 v96, 16, v96
    v_mul_f32 v124, v96, v123
    v_fma_f32 v125, -v124, v122, v96
    v_fma_f32 v96, v125, v123, v124
    v_sub_f32 v97, v97, v120
    v_cvt_pk_bf16_f32 v97, v97, v97
    v_lshlrev_b32 v97, 16, v97
    v_mul_f32 v124, v97, v123
    v_fma_f32 v125, -v124, v122, v97
    v_fma_f32 v97, v125, v123, v124
    v_sub_f32 v98, v98, v120
    v_cvt_pk_bf16_f32 v98, v98, v98
    v_lshlrev_b32 v98, 16, v98
    v_mul_f32 v124, v98, v123
    v_fma_f32 v125, -v124, v122, v98
    v_fma_f32 v98, v125, v123, v124
    v_sub_f32 v99, v99, v120
    v_cvt_pk_bf16_f32 v99, v99, v99
    v_lshlrev_b32 v99, 16, v99
    v_mul_f32 v124, v99, v123
    v_fma_f32 v125, -v124, v122, v99
    v_fma_f32 v99, v125, v123, v124
    v_sub_f32 v100, v100, v120
    v_cvt_pk_bf16_f32 v100, v100, v100
    v_lshlrev_b32 v100, 16, v100
    v_mul_f32 v124, v100, v123
    v_fma_f32 v125, -v124, v122, v100
    v_fma_f32 v100, v125, v123, v124
    v_sub_f32 v101, v101, v120
    v_cvt_pk_bf16_f32 v101, v101, v101
    v_lshlrev_b32 v101, 16, v101
    v_mul_f32 v124, v101, v123
    v_fma_f32 v125, -v124, v122, v101
    v_fma_f32 v101, v125, v123, v124
    v_sub_f32 v102, v102, v120
    v_cvt_pk_bf16_f32 v102, v102, v102
    v_lshlrev_b32 v102, 16, v102
    v_mul_f32 v124, v102, v123
    v_fma_f32 v125, -v124, v122, v102
    v_fma_f32 v102, v125, v123, v124
    v_sub_f32 v103, v103, v120
    v_cvt_pk_bf16_f32 v103, v103, v103
    v_lshlrev_b32 v103, 16, v103
    v_mul_f32 v124, v103, v123
    v_fma_f32 v125, -v124, v122, v103
    v_fma_f32 v103, v125, v123, v124
    v_cvt_pk_bf16_f32 v112, v96, v97
    v_cvt_pk_bf16_f32 v113, v98, v99
    v_cvt_pk_bf16_f32 v114, v100, v101
    v_cvt_pk_bf16_f32 v115, v102, v103
    v_lshlrev_b32 v104, 16, v116
    v_and_b32 v105, 0xffff0000, v116
    v_lshlrev_b32 v106, 16, v117
    v_and_b32 v107, 0xffff0000, v117
    v_lshlrev_b32 v108, 16, v118
    v_and_b32 v109, 0xffff0000, v118
    v_lshlrev_b32 v110, 16, v119
    v_and_b32 v111, 0xffff0000, v119
    v_add_f32 v126, v104, v105
    v_add_f32 v127, v106, v107
    v_add_f32 v128, v108, v109
    v_add_f32 v129, v110, v111
    v_add_f32 v126, v126, v127
    v_add_f32 v128, v128, v129
    v_add_f32 v126, v126, v128
    s_nop 1
    v_add_f32 v126, v126, v126 quad_perm:[1,0,3,2]
    s_nop 1
    v_add_f32 v126, v126, v126 quad_perm:[2,3,0,1]
    s_nop 1
    v_add_f32 v126, v126, v126 row_half_mirror
    s_nop 1
    v_add_f32 v126, v126, v126 row_mirror
    v_mov_b32 v127, v126
    s_nop 1
    v_permlane16_swap_b32 v126, v127
    v_add_f32 v126, v126, v127
    v_mov_b32 v127, v126
    s_nop 1
    v_permlane32_swap_b32 v126, v127
    v_add_f32 v126, v126, v127
    v_mul_f32 v126, 0x3b124925, v126
    v_mov_b32 v128, 0
    v_sub_f32 v129, v104, v126
    v_fmac_f32 v128, v129, v129
    v_sub_f32 v129, v105, v126
    v_fmac_f32 v128, v129, v129
    v_sub_f32 v129, v106, v126
    v_fmac_f32 v128, v129, v129
    v_sub_f32 v129, v107, v126
    v_fmac_f32 v128, v129, v129
    v_sub_f32 v129, v108, v126
    v_fmac_f32 v128, v129, v129
    v_sub_f32 v129, v109, v126
    v_fmac_f32 v128, v129, v129
    v_sub_f32 v129, v110, v126
    v_fmac_f32 v128, v129, v129
    v_sub_f32 v129, v111, v126
    v_fmac_f32 v128, v129, v129
    v_cndmask_b32 v128, 0, v128, vcc
    s_nop 1
    v_add_f32 v128, v128, v128 quad_perm:[1,0,3,2]
    s_nop 1
    v_add_f32 v128, v128, v128 quad_perm:[2,3,0,1]
    s_nop 1
    v_add_f32 v128, v128, v128 row_half_mirror
    s_nop 1
    v_add_f32 v128, v128, v128 row_mirror
    v_mov_b32 v127, v128
    s_nop 1
    v_permlane16_swap_b32 v128, v127
    v_add_f32 v128, v128, v127
    v_mov_b32 v127, v128
    s_nop 1
    v_permlane32_swap_b32 v128, v127
    v_add_f32 v128, v128, v127
    v_mul_f32 v128, 0x3b124925, v128
    v_cvt_pk_bf16_f32 v126, v126, v126
    v_lshlrev_b32 v126, 16, v126
    v_cvt_pk_bf16_f32 v128, v128, v128
    v_lshlrev_b32 v128, 16, v128
    v_add_f32 v128, 0x3727c5ac, v128
    v_cvt_pk_bf16_f32 v128, v128, v128
    v_lshlrev_b32 v128, 16, v128
    v_sqrt_f32 v128, v128
    s_nop 0
    v_cvt_pk_bf16_f32 v128, v128, v128
    v_lshlrev_b32 v128, 16, v128
    v_rcp_f32 v129, v128
    v_sub_f32 v104, v104, v126
    v_cvt_pk_bf16_f32 v104, v104, v104
    v_lshlrev_b32 v104, 16, v104
    v_mul_f32 v130, v104, v129
    v_fma_f32 v131, -v130, v128, v104
    v_fma_f32 v104, v131, v129, v130
    v_sub_f32 v105, v105, v126
    v_cvt_pk_bf16_f32 v105, v105, v105
    v_lshlrev_b32 v105, 16, v105
    v_mul_f32 v130, v105, v129
    v_fma_f32 v131, -v130, v128, v105
    v_fma_f32 v105, v131, v129, v130
    v_sub_f32 v106, v106, v126
    v_cvt_pk_bf16_f32 v106, v106, v106
    v_lshlrev_b32 v106, 16, v106
    v_mul_f32 v130, v106, v129
    v_fma_f32 v131, -v130, v128, v106
    v_fma_f32 v106, v131, v129, v130
    v_sub_f32 v107, v107, v126
    v_cvt_pk_bf16_f32 v107, v107, v107
    v_lshlrev_b32 v107, 16, v107
    v_mul_f32 v130, v107, v129
    v_fma_f32 v131, -v130, v128, v107
    v_fma_f32 v107, v131, v129, v130
    v_sub_f32 v108, v108, v126
    v_cvt_pk_bf16_f32 v108, v108, v108
    v_lshlrev_b32 v108, 16, v108
    v_mul_f32 v130, v108, v129
    v_fma_f32 v131, -v130, v128, v108
    v_fma_f32 v108, v131, v129, v130
    v_sub_f32 v109, v109, v126
    v_cvt_pk_bf16_f32 v109, v109, v109
    v_lshlrev_b32 v109, 16, v109
    v_mul_f32 v130, v109, v129
    v_fma_f32 v131, -v130, v128, v109
    v_fma_f32 v109, v131, v129, v130
    v_sub_f32 v110, v110, v126
    v_cvt_pk_bf16_f32 v110, v110, v110
    v_lshlrev_b32 v110, 16, v110
    v_mul_f32 v130, v110, v129
    v_fma_f32 v131, -v130, v128, v110
    v_fma_f32 v110, v131, v129, v130
    v_sub_f32 v111, v111, v126
    v_cvt_pk_bf16_f32 v111, v111, v111
    v_lshlrev_b32 v111, 16, v111
    v_mul_f32 v130, v111, v129
    v_fma_f32 v131, -v130, v128, v111
    v_fma_f32 v111, v131, v129, v130
    v_cvt_pk_bf16_f32 v116, v104, v105
    v_cvt_pk_bf16_f32 v117, v106, v107
    v_cvt_pk_bf16_f32 v118, v108, v109
    v_cvt_pk_bf16_f32 v119, v110, v111
    s_mul_i32 s63, s3, 1792
    v_add_u32 v31, s63, v2
    s_and_saveexec_b64 s[76:77], vcc
    ds_write_b128 v31, v[112:115] offset:28672
    ds_write_b128 v31, v[116:119] offset:29568
    s_mov_b64 exec, s[76:77]
    s_cmp_eq_u32 s3, 0
    s_cbranch_scc1 LA_w0b
    s_waitcnt vmcnt(8) lgkmcnt(0)
    s_barrier
    s_add_u32 m0, s62, 8192
    s_add_u32 s63, s61, 8192
    buffer_load_dwordx4 v4, s[8:11], s63 offen offset:0 nt lds
    buffer_load_dwordx4 v5, s[8:11], s63 offen offset:1024 nt lds
    buffer_load_dwordx4 v6, s[8:11], s63 offen offset:2048 nt lds
    buffer_load_dwordx4 v7, s[8:11], s63 offen offset:3072 nt lds
    s_add_u32 m0, s62, 12288
    s_add_u32 s63, s61, 12288
    buffer_load_dwordx4 v4, s[8:11], s63 offen offset:0 nt lds
    buffer_load_dwordx4 v5, s[8:11], s63 offen offset:1024 nt lds
    buffer_load_dwordx4 v6, s[8:11], s63 offen offset:2048 nt lds
    buffer_load_dwordx4 v7, s[8:11], s63 offen offset:3072 nt lds
    s_add_u32 m0, s62, 16384
    s_add_u32 s63, s61, 0
    buffer_load_dwordx4 v4, s[12:15], s63 offen offset:0 nt lds
    buffer_load_dwordx4 v5, s[12:15], s63 offen offset:1024 nt lds
    buffer_load_dwordx4 v6, s[12:15], s63 offen offset:2048 nt lds
    buffer_load_dwordx4 v7, s[12:15], s63 offen offset:3072 nt lds
    s_add_u32 m0, s62, 20480
    s_add_u32 s63, s61, 4096
    buffer_load_dwordx4 v4, s[12:15], s63 offen offset:0 nt lds
    buffer_load_dwordx4 v5, s[12:15], s63 offen offset:1024 nt lds
    buffer_load_dwordx4 v6, s[12:15], s63 offen offset:2048 nt lds
    buffer_load_dwordx4 v7, s[12:15], s63 offen offset:3072 nt lds
    s_add_u32 m0, s62, 24576
    s_add_u32 s63, s61, 8192
    buffer_load_dwordx4 v4, s[12:15], s63 offen offset:0 nt lds
    buffer_load_dwordx4 v5, s[12:15], s63 offen offset:1024 nt lds
    buffer_load_dwordx4 v6, s[12:15], s63 offen offset:2048 nt lds
    buffer_load_dwordx4 v7, s[12:15], s63 offen offset:3072 nt lds
    s_add_u32 m0, s62, 28672
    s_add_u32 s63, s61, 12288
    buffer_load_dwordx4 v4, s[12:15], s63 offen offset:0 nt lds
    buffer_load_dwordx4 v5, s[12:15], s63 offen offset:1024 nt lds
    buffer_load_dwordx4 v6, s[12:15], s63 offen offset:2048 nt lds
    buffer_load_dwordx4 v7, s[12:15], s63 offen offset:3072 nt lds
    s_branch LA_wait
LA_w0b:
    s_waitcnt vmcnt(0) lgkmcnt(0)
    s_barrier
    v_and_b32 v31, 7, v1
    v_mul_u32_u24 v31, 896, v31
    v_add_u32 v31, v31, v30
    v_lshrrev_b32 v29, 2, v1
    v_lshlrev_b32 v29, 6, v29
    v_lshl_add_u32 v29, v28, 3, v29
    ds_read_b64 v[64:65], v31 offset:28672
    ds_read_b64_tr_b16 v[120:121], v29 offset:0
    ds_read_b64_tr_b16 v[176:177], v29 offset:32
    ds_read_b64 v[66:67], v31 offset:28704
    ds_read_b64_tr_b16 v[122:123], v29 offset:1024
    ds_read_b64_tr_b16 v[178:179], v29 offset:1056
    ds_read_b64 v[68:69], v31 offset:28736
    ds_read_b64_tr_b16 v[124:125], v29 offset:2048
    ds_read_b64_tr_b16 v[180:181], v29 offset:2080
    ds_read_b64 v[70:71], v31 offset:28768
    ds_read_b64_tr_b16 v[126:127], v29 offset:3072
    ds_read_b64_tr_b16 v[182:183], v29 offset:3104
    ds_read_b64 v[72:73], v31 offset:28800
    ds_read_b64_tr_b16 v[128:129], v29 offset:4096
    ds_read_b64_tr_b16 v[184:185], v29 offset:4128
    ds_read_b64 v[74:75], v31 offset:28832
    ds_read_b64_tr_b16 v[130:131], v29 offset:5120
    ds_read_b64_tr_b16 v[186:187], v29 offset:5152
    ds_read_b64 v[76:77], v31 offset:28864
    ds_read_b64_tr_b16 v[132:133], v29 offset:6144
    ds_read_b64_tr_b16 v[188:189], v29 offset:6176
    ds_read_b64 v[78:79], v31 offset:28896
    ds_read_b64_tr_b16 v[134:135], v29 offset:7168
    ds_read_b64_tr_b16 v[190:191], v29 offset:7200
    ds_read_b64 v[80:81], v31 offset:28928
    ds_read_b64_tr_b16 v[136:137], v29 offset:8192
    ds_read_b64_tr_b16 v[192:193], v29 offset:8224
    ds_read_b64 v[82:83], v31 offset:28960
    ds_read_b64_tr_b16 v[138:139], v29 offset:9216
    ds_read_b64_tr_b16 v[194:195], v29 offset:9248
    ds_read_b64 v[84:85], v31 offset:28992
    ds_read_b64_tr_b16 v[140:141], v29 offset:10240
    ds_read_b64_tr_b16 v[196:197], v29 offset:10272
    ds_read_b64 v[86:87], v31 offset:29024
    ds_read_b64_tr_b16 v[142:143], v29 offset:11264
    ds_read_b64_tr_b16 v[198:199], v29 offset:11296
    ds_read_b64 v[88:89], v31 offset:29056
    ds_read_b64_tr_b16 v[144:145], v29 offset:12288
    ds_read_b64_tr_b16 v[200:201], v29 offset:12320
    ds_read_b64 v[90:91], v31 offset:29088
    ds_read_b64_tr_b16 v[146:147], v29 offset:13312
    ds_read_b64_tr_b16 v[202:203], v29 offset:13344
    ds_read_b64 v[92:93], v31 offset:29120
    ds_read_b64_tr_b16 v[148:149], v29 offset:14336
    ds_read_b64_tr_b16 v[204:205], v29 offset:14368
    ds_read_b64 v[94:95], v31 offset:29152
    ds_read_b64_tr_b16 v[150:151], v29 offset:15360
    ds_read_b64_tr_b16 v[206:207], v29 offset:15392
    ds_read_b64 v[96:97], v31 offset:29184
    ds_read_b64_tr_b16 v[152:153], v29 offset:16384
    ds_read_b64_tr_b16 v[208:209], v29 offset:16416
    ds_read_b64 v[98:99], v31 offset:29216
    ds_read_b64_tr_b16 v[154:155], v29 offset:17408
    ds_read_b64_tr_b16 v[210:211], v29 offset:17440
    ds_read_b64 v[100:101], v31 offset:29248
    ds_read_b64_tr_b16 v[156:157], v29 offset:18432
    ds_read_b64_tr_b16 v[212:213], v29 offset:18464
    ds_read_b64 v[102:103], v31 offset:29280
    ds_read_b64_tr_b16 v[158:159], v29 offset:19456
    ds_read_b64_tr_b16 v[214:215], v29 offset:19488
    ds_read_b64 v[104:105], v31 offset:29312
    ds_read_b64_tr_b16 v[160:161], v29 offset:20480
    ds_read_b64_tr_b16 v[216:217], v29 offset:20512
    ds_read_b64 v[106:107], v31 offset:29344
    ds_read_b64_tr_b16 v[162:163], v29 offset:21504
    ds_read_b64_tr_b16 v[218:219], v29 offset:21536
    ds_read_b64 v[108:109], v31 offset:29376
    ds_read_b64_tr_b16 v[164:165], v29 offset:22528
    ds_read_b64_tr_b16 v[220:221], v29 offset:22560
    ds_read_b64 v[110:111], v31 offset:29408
    ds_read_b64_tr_b16 v[166:167], v29 offset:23552
    ds_read_b64_tr_b16 v[222:223], v29 offset:23584
    ds_read_b64 v[112:113], v31 offset:29440
    ds_read_b64_tr_b16 v[168:169], v29 offset:24576
    ds_read_b64_tr_b16 v[224:225], v29 offset:24608
    ds_read_b64 v[114:115], v31 offset:29472
    ds_read_b64_tr_b16 v[170:171], v29 offset:25600
    ds_read_b64_tr_b16 v[226:227], v29 offset:25632
    ds_read_b64 v[116:117], v31 offset:29504
    ds_read_b64_tr_b16 v[172:173], v29 offset:26624
    ds_read_b64_tr_b16 v[228:229], v29 offset:26656
    ds_read_b64 v[118:119], v31 offset:29536
    ds_read_b64_tr_b16 v[174:175], v29 offset:27648
    ds_read_b64_tr_b16 v[230:231], v29 offset:27680
    s_waitcnt lgkmcnt(0)
    v_mfma_f32_16x16x32_bf16 v[232:235], v[120:123], v[64:67], 0
    v_mfma_f32_16x16x32_bf16 v[236:239], v[176:179], v[64:67], 0
    v_mfma_f32_16x16x32_bf16 v[232:235], v[124:127], v[68:71], v[232:235]
    v_mfma_f32_16x16x32_bf16 v[236:239], v[180:183], v[68:71], v[236:239]
    v_mfma_f32_16x16x32_bf16 v[232:235], v[128:131], v[72:75], v[232:235]
    v_mfma_f32_16x16x32_bf16 v[236:239], v[184:187], v[72:75], v[236:239]
    v_mfma_f32_16x16x32_bf16 v[232:235], v[132:135], v[76:79], v[232:235]
    v_mfma_f32_16x16x32_bf16 v[236:239], v[188:191], v[76:79], v[236:239]
    v_mfma_f32_16x16x32_bf16 v[232:235], v[136:139], v[80:83], v[232:235]
    v_mfma_f32_16x16x32_bf16 v[236:239], v[192:195], v[80:83], v[236:239]
    v_mfma_f32_16x16x32_bf16 v[232:235], v[140:143], v[84:87], v[232:235]
    v_mfma_f32_16x16x32_bf16 v[236:239], v[196:199], v[84:87], v[236:239]
    v_mfma_f32_16x16x32_bf16 v[232:235], v[144:147], v[88:91], v[232:235]
    v_mfma_f32_16x16x32_bf16 v[236:239], v[200:203], v[88:91], v[236:239]
    v_mfma_f32_16x16x32_bf16 v[232:235], v[148:151], v[92:95], v[232:235]
    v_mfma_f32_16x16x32_bf16 v[236:239], v[204:207], v[92:95], v[236:239]
    v_mfma_f32_16x16x32_bf16 v[232:235], v[152:155], v[96:99], v[232:235]
    v_mfma_f32_16x16x32_bf16 v[236:239], v[208:211], v[96:99], v[236:239]
    v_mfma_f32_16x16x32_bf16 v[232:235], v[156:159], v[100:103], v[232:235]
    v_mfma_f32_16x16x32_bf16 v[236:239], v[212:215], v[100:103], v[236:239]
    v_mfma_f32_16x16x32_bf16 v[232:235], v[160:163], v[104:107], v[232:235]
    v_mfma_f32_16x16x32_bf16 v[236:239], v[216:219], v[104:107], v[236:239]
    v_mfma_f32_16x16x32_bf16 v[232:235], v[164:167], v[108:111], v[232:235]
    v_mfma_f32_16x16x32_bf16 v[236:239], v[220:223], v[108:111], v[236:239]
    v_mfma_f32_16x16x32_bf16 v[232:235], v[168:171], v[112:115], v[232:235]
    v_mfma_f32_16x16x32_bf16 v[236:239], v[224:227], v[112:115], v[236:239]
    v_mfma_f32_16x16x32_bf16 v[232:235], v[172:175], v[116:119], v[232:235]
    v_mfma_f32_16x16x32_bf16 v[236:239], v[228:231], v[116:119], v[236:239]
    v_and_b32 v29, 15, v1
    s_nop 7
    s_cmp_ge_u32 s2, 128
    s_cbranch_scc1 LA_ph
    v_lshl_add_u32 v31, v29, 13, v30
    s_add_u32 s63, s68, 1179648
    v_cvt_pk_bf16_f32 v232, v232, v233
    v_cvt_pk_bf16_f32 v233, v234, v235
    v_cvt_pk_bf16_f32 v236, v236, v237
    v_cvt_pk_bf16_f32 v237, v238, v239
    v_cmp_gt_u32 vcc, 8, v29
    s_and_saveexec_b64 s[76:77], vcc
    buffer_store_dwordx2 v[232:233], v31, s[28:31], s63 offen offset:0 sc1
    buffer_store_dwordx2 v[236:237], v31, s[28:31], s63 offen offset:32 sc1
    s_and_b32 s63, s2, 31
    s_lshr_b32 s65, s63, 2
    s_lshl_b32 s65, s65, 4
    s_and_b32 s63, s63, 3
    s_add_u32 s65, s65, s63
    s_lshr_b32 s63, s2, 5
    s_lshl_b32 s63, s63, 2
    s_add_u32 s65, s65, s63
    s_lshl_b32 s65, s65, 8
    s_add_u32 s65, s65, 1310720
    s_mov_b64 exec, 1
    v_mov_b32 v31, 0
    buffer_store_dword v31, v31, s[28:31], s65 offen sc1
LA_nz:
    s_mov_b64 exec, s[76:77]
    s_waitcnt vmcnt(0)
    s_lshr_b32 s63, s2, 5
    s_lshl_b32 s63, s63, 6
    s_mov_b32 s65, 1
    s_atomic_add s65, s[52:53], s63
    s_branch LA_noP
LA_ph:
    v_mov_b32 v31, 0x3d372713
    v_lshlrev_b32 v23, 16, v24
    v_cvt_pk_bf16_f32 v232, v232, v232
    v_lshlrev_b32 v232, 16, v232
    v_add_f32 v232, v232, v23
    v_cvt_pk_bf16_f32 v232, v232, v232
    v_lshlrev_b32 v232, 16, v232
    v_mul_f32 v23, v232, v232
    v_mul_f32 v23, v23, v232
    v_fma_f32 v23, v23, v31, v232
    v_mul_f32 v23, 0xc0135761, v23
    v_exp_f32 v23, v23
    s_nop 0
    v_add_f32 v23, 1.0, v23
    v_rcp_f32 v23, v23
    s_nop 0
    v_mul_f32 v232, v232, v23
    v_and_b32 v23, 0xffff0000, v24
    v_cvt_pk_bf16_f32 v233, v233, v233
    v_lshlrev_b32 v233, 16, v233
    v_add_f32 v233, v233, v23
    v_cvt_pk_bf16_f32 v233, v233, v233
    v_lshlrev_b32 v233, 16, v233
    v_mul_f32 v23, v233, v233
    v_mul_f32 v23, v23, v233
    v_fma_f32 v23, v23, v31, v233
    v_mul_f32 v23, 0xc0135761, v23
    v_exp_f32 v23, v23
    s_nop 0
    v_add_f32 v23, 1.0, v23
    v_rcp_f32 v23, v23
    s_nop 0
    v_mul_f32 v233, v233, v23
    v_lshlrev_b32 v23, 16, v25
    v_cvt_pk_bf16_f32 v234, v234, v234
    v_lshlrev_b32 v234, 16, v234
    v_add_f32 v234, v234, v23
    v_cvt_pk_bf16_f32 v234, v234, v234
    v_lshlrev_b32 v234, 16, v234
    v_mul_f32 v23, v234, v234
    v_mul_f32 v23, v23, v234
    v_fma_f32 v23, v23, v31, v234
    v_mul_f32 v23, 0xc0135761, v23
    v_exp_f32 v23, v23
    s_nop 0
    v_add_f32 v23, 1.0, v23
    v_rcp_f32 v23, v23
    s_nop 0
    v_mul_f32 v234, v234, v23
    v_and_b32 v23, 0xffff0000, v25
    v_cvt_pk_bf16_f32 v235, v235, v235
    v_lshlrev_b32 v235, 16, v235
    v_add_f32 v235, v235, v23
    v_cvt_pk_bf16_f32 v235, v235, v235
    v_lshlrev_b32 v235, 16, v235
    v_mul_f32 v23, v235, v235
    v_mul_f32 v23, v23, v235
    v_fma_f32 v23, v23, v31, v235
    v_mul_f32 v23, 0xc0135761, v23
    v_exp_f32 v23, v23
    s_nop 0
    v_add_f32 v23, 1.0, v23
    v_rcp_f32 v23, v23
    s_nop 0
    v_mul_f32 v235, v235, v23
    v_cvt_pk_bf16_f32 v232, v232, v233
    v_cvt_pk_bf16_f32 v233, v234, v235
    v_lshlrev_b32 v23, 16, v26
    v_cvt_pk_bf16_f32 v236, v236, v236
    v_lshlrev_b32 v236, 16, v236
    v_add_f32 v236, v236, v23
    v_cvt_pk_bf16_f32 v236, v236, v236
    v_lshlrev_b32 v236, 16, v236
    v_mul_f32 v23, v236, v236
    v_mul_f32 v23, v23, v236
    v_fma_f32 v23, v23, v31, v236
    v_mul_f32 v23, 0xc0135761, v23
    v_exp_f32 v23, v23
    s_nop 0
    v_add_f32 v23, 1.0, v23
    v_rcp_f32 v23, v23
    s_nop 0
    v_mul_f32 v236, v236, v23
    v_and_b32 v23, 0xffff0000, v26
    v_cvt_pk_bf16_f32 v237, v237, v237
    v_lshlrev_b32 v237, 16, v237
    v_add_f32 v237, v237, v23
    v_cvt_pk_bf16_f32 v237, v237, v237
    v_lshlrev_b32 v237, 16, v237
    v_mul_f32 v23, v237, v237
    v_mul_f32 v23, v23, v237
    v_fma_f32 v23, v23, v31, v237
    v_mul_f32 v23, 0xc0135761, v23
    v_exp_f32 v23, v23
    s_nop 0
    v_add_f32 v23, 1.0, v23
    v_rcp_f32 v23, v23
    s_nop 0
    v_mul_f32 v237, v237, v23
    v_lshlrev_b32 v23, 16, v27
    v_cvt_pk_bf16_f32 v238, v238, v238
    v_lshlrev_b32 v238, 16, v238
    v_add_f32 v238, v238, v23
    v_cvt_pk_bf16_f32 v238, v238, v238
    v_lshlrev_b32 v238, 16, v238
    v_mul_f32 v23, v238, v238
    v_mul_f32 v23, v23, v238
    v_fma_f32 v23, v23, v31, v238
    v_mul_f32 v23, 0xc0135761, v23
    v_exp_f32 v23, v23
    s_nop 0
    v_add_f32 v23, 1.0, v23
    v_rcp_f32 v23, v23
    s_nop 0
    v_mul_f32 v238, v238, v23
    v_and_b32 v23, 0xffff0000, v27
    v_cvt_pk_bf16_f32 v239, v239, v239
    v_lshlrev_b32 v239, 16, v239
    v_add_f32 v239, v239, v23
    v_cvt_pk_bf16_f32 v239, v239, v239
    v_lshlrev_b32 v239, 16, v239
    v_mul_f32 v23, v239, v239
    v_mul_f32 v23, v23, v239
    v_fma_f32 v23, v23, v31, v239
    v_mul_f32 v23, 0xc0135761, v23
    v_exp_f32 v23, v23
    s_nop 0
    v_add_f32 v23, 1.0, v23
    v_rcp_f32 v23, v23
    s_nop 0
    v_mul_f32 v239, v239, v23
    v_cvt_pk_bf16_f32 v236, v236, v237
    v_cvt_pk_bf16_f32 v237, v238, v239
    v_mul_u32_u24 v31, 3584, v29
    v_add_u32 v31, v31, v30
    s_add_u32 s63, s68, 1114112
    v_cmp_gt_u32 vcc, 8, v29
    s_and_saveexec_b64 s[76:77], vcc
    buffer_store_dwordx2 v[232:233], v31, s[28:31], s63 offen offset:0
    buffer_store_dwordx2 v[236:237], v31, s[28:31], s63 offen offset:32
    s_mov_b64 exec, s[76:77]
LA_noP:
    s_add_u32 m0, s62, 0
    s_add_u32 s63, s61, 0
    buffer_load_dwordx4 v4, s[8:11], s63 offen offset:0 nt lds
    buffer_load_dwordx4 v5, s[8:11], s63 offen offset:1024 nt lds
    buffer_load_dwordx4 v6, s[8:11], s63 offen offset:2048 nt lds
    buffer_load_dwordx4 v7, s[8:11], s63 offen offset:3072 nt lds
    s_add_u32 m0, s62, 4096
    s_add_u32 s63, s61, 4096
    buffer_load_dwordx4 v4, s[8:11], s63 offen offset:0 nt lds
    buffer_load_dwordx4 v5, s[8:11], s63 offen offset:1024 nt lds
    buffer_load_dwordx4 v6, s[8:11], s63 offen offset:2048 nt lds
    buffer_load_dwordx4 v7, s[8:11], s63 offen offset:3072 nt lds
    s_add_u32 m0, s62, 8192
    s_add_u32 s63, s61, 8192
    buffer_load_dwordx4 v4, s[8:11], s63 offen offset:0 nt lds
    buffer_load_dwordx4 v5, s[8:11], s63 offen offset:1024 nt lds
    buffer_load_dwordx4 v6, s[8:11], s63 offen offset:2048 nt lds
    buffer_load_dwordx4 v7, s[8:11], s63 offen offset:3072 nt lds
    s_add_u32 m0, s62, 12288
    s_add_u32 s63, s61, 12288
    buffer_load_dwordx4 v4, s[8:11], s63 offen offset:0 nt lds
    buffer_load_dwordx4 v5, s[8:11], s63 offen offset:1024 nt lds
    buffer_load_dwordx4 v6, s[8:11], s63 offen offset:2048 nt lds
    buffer_load_dwordx4 v7, s[8:11], s63 offen offset:3072 nt lds
    s_add_u32 m0, s62, 16384
    s_add_u32 s63, s61, 0
    buffer_load_dwordx4 v4, s[12:15], s63 offen offset:0 nt lds
    buffer_load_dwordx4 v5, s[12:15], s63 offen offset:1024 nt lds
    buffer_load_dwordx4 v6, s[12:15], s63 offen offset:2048 nt lds
    buffer_load_dwordx4 v7, s[12:15], s63 offen offset:3072 nt lds
    s_add_u32 m0, s62, 20480
    s_add_u32 s63, s61, 4096
    buffer_load_dwordx4 v4, s[12:15], s63 offen offset:0 nt lds
    buffer_load_dwordx4 v5, s[12:15], s63 offen offset:1024 nt lds
    buffer_load_dwordx4 v6, s[12:15], s63 offen offset:2048 nt lds
    buffer_load_dwordx4 v7, s[12:15], s63 offen offset:3072 nt lds
    s_add_u32 m0, s62, 24576
    s_add_u32 s63, s61, 8192
    buffer_load_dwordx4 v4, s[12:15], s63 offen offset:0 nt lds
    buffer_load_dwordx4 v5, s[12:15], s63 offen offset:1024 nt lds
    buffer_load_dwordx4 v6, s[12:15], s63 offen offset:2048 nt lds
    buffer_load_dwordx4 v7, s[12:15], s63 offen offset:3072 nt lds
    s_add_u32 m0, s62, 28672
    s_add_u32 s63, s61, 12288
    buffer_load_dwordx4 v4, s[12:15], s63 offen offset:0 nt lds
    buffer_load_dwordx4 v5, s[12:15], s63 offen offset:1024 nt lds
    buffer_load_dwordx4 v6, s[12:15], s63 offen offset:2048 nt lds
    buffer_load_dwordx4 v7, s[12:15], s63 offen offset:3072 nt lds
LA_wait:
    s_add_u32 s61, s61, 131072
    s_add_u32 s63, s61, 0
    buffer_load_dwordx4 a[0:3], v4, s[8:11], s63 offen offset:0 nt
    buffer_load_dwordx4 a[4:7], v5, s[8:11], s63 offen offset:1024 nt
    buffer_load_dwordx4 a[8:11], v6, s[8:11], s63 offen offset:2048 nt
    buffer_load_dwordx4 a[12:15], v7, s[8:11], s63 offen offset:3072 nt
    s_add_u32 s63, s61, 4096
    buffer_load_dwordx4 a[16:19], v4, s[8:11], s63 offen offset:0 nt
    buffer_load_dwordx4 a[20:23], v5, s[8:11], s63 offen offset:1024 nt
    buffer_load_dwordx4 a[24:27], v6, s[8:11], s63 offen offset:2048 nt
    buffer_load_dwordx4 a[28:31], v7, s[8:11], s63 offen offset:3072 nt
    s_add_u32 s63, s61, 8192
    buffer_load_dwordx4 a[32:35], v4, s[8:11], s63 offen offset:0 nt
    buffer_load_dwordx4 a[36:39], v5, s[8:11], s63 offen offset:1024 nt
    buffer_load_dwordx4 a[40:43], v6, s[8:11], s63 offen offset:2048 nt
    buffer_load_dwordx4 a[44:47], v7, s[8:11], s63 offen offset:3072 nt
    s_add_u32 s63, s61, 12288
    buffer_load_dwordx4 a[48:51], v4, s[8:11], s63 offen offset:0 nt
    buffer_load_dwordx4 a[52:55], v5, s[8:11], s63 offen offset:1024 nt
    buffer_load_dwordx4 a[56:59], v6, s[8:11], s63 offen offset:2048 nt
    buffer_load_dwordx4 a[60:63], v7, s[8:11], s63 offen offset:3072 nt
    s_waitcnt vmcnt(47)
    s_add_u32 s63, s61, 0
    buffer_load_dwordx4 a[64:67], v4, s[12:15], s63 offen offset:0 nt
    buffer_load_dwordx4 a[68:71], v5, s[12:15], s63 offen offset:1024 nt
    buffer_load_dwordx4 a[72:75], v6, s[12:15], s63 offen offset:2048 nt
    buffer_load_dwordx4 a[76:79], v7, s[12:15], s63 offen offset:3072 nt
    s_add_u32 s63, s61, 4096
    buffer_load_dwordx4 a[80:83], v4, s[12:15], s63 offen offset:0 nt
    buffer_load_dwordx4 a[84:87], v5, s[12:15], s63 offen offset:1024 nt
    buffer_load_dwordx4 a[88:91], v6, s[12:15], s63 offen offset:2048 nt
    buffer_load_dwordx4 a[92:95], v7, s[12:15], s63 offen offset:3072 nt
    s_add_u32 s63, s61, 8192
    buffer_load_dwordx4 a[96:99], v4, s[12:15], s63 offen offset:0 nt
    buffer_load_dwordx4 a[100:103], v5, s[12:15], s63 offen offset:1024 nt
    buffer_load_dwordx4 a[104:107], v6, s[12:15], s63 offen offset:2048 nt
    buffer_load_dwordx4 a[108:111], v7, s[12:15], s63 offen offset:3072 nt
    s_add_u32 s63, s61, 12288
    buffer_load_dwordx4 a[112:115], v4, s[12:15], s63 offen offset:0 nt
    buffer_load_dwordx4 a[116:119], v5, s[12:15], s63 offen offset:1024 nt
    buffer_load_dwordx4 a[120:123], v6, s[12:15], s63 offen offset:2048 nt
    buffer_load_dwordx4 a[124:127], v7, s[12:15], s63 offen offset:3072 nt
    v_add_u32 v31, s62, v2
    v_and_b32 v23, 15, v1
    v_lshrrev_b32 v24, 4, v1
    v_and_b32 v25, 7, v23
    v_lshlrev_b32 v25, 1, v25
    v_xor_b32 v25, v25, v24
    v_lshlrev_b32 v25, 4, v25
    v_lshl_add_u32 v25, v23, 9, v25
    v_add_u32 v8, s62, v25
    v_xor_b32 v9, 64, v8
    v_xor_b32 v10, 128, v8
    v_xor_b32 v11, 192, v8
    v_lshlrev_b32 v27, 4, v24
    v_lshl_add_u32 v27, v23, 9, v27
    v_mov_b32 v26, 0x40000000
    v_cmp_gt_u32 vcc, 2, v23
    s_nop 1
    v_cndmask_b32 v27, v26, v27, vcc
    v_lshrrev_b32 v23, 2, v1
    v_and_b32 v25, 7, v23
    v_lshlrev_b32 v25, 1, v25
    v_bfe_u32 v26, v1, 1, 1
    v_or_b32 v25, v25, v26
    v_lshlrev_b32 v25, 4, v25
    v_and_b32 v26, 1, v1
    v_lshl_add_u32 v25, v26, 3, v25
    v_lshl_add_u32 v25, v23, 9, v25
    v_add_u32 v25, s62, v25
    v_add_u32 v12, 16384, v25
    v_xor_b32 v13, 32, v12
    v_xor_b32 v14, 64, v12
    v_xor_b32 v15, 96, v12
    v_xor_b32 v16, 128, v12
    v_xor_b32 v17, 160, v12
    v_xor_b32 v18, 192, v12
    v_xor_b32 v19, 224, v12
    s_mov_b32 s74, 0x3db8aa3b
    v_mov_b32 v192, 0
    v_mov_b32 v193, 0
    v_mov_b32 v194, 0
    v_mov_b32 v195, 0
    v_mov_b32 v196, 0
    v_mov_b32 v197, 0
    v_mov_b32 v198, 0
    v_mov_b32 v199, 0
    v_mov_b32 v200, 0
    v_mov_b32 v201, 0
    v_mov_b32 v202, 0
    v_mov_b32 v203, 0
    v_mov_b32 v204, 0
    v_mov_b32 v205, 0
    v_mov_b32 v206, 0
    v_mov_b32 v207, 0
    v_mov_b32 v208, 0
    v_mov_b32 v209, 0
    v_mov_b32 v210, 0
    v_mov_b32 v211, 0
    v_mov_b32 v212, 0
    v_mov_b32 v213, 0
    v_mov_b32 v214, 0
    v_mov_b32 v215, 0
    v_mov_b32 v216, 0
    v_mov_b32 v217, 0
    v_mov_b32 v218, 0
    v_mov_b32 v219, 0
    v_mov_b32 v220, 0
    v_mov_b32 v221, 0
    v_mov_b32 v222, 0
    v_mov_b32 v223, 0
    v_mov_b32 v224, 0
    v_mov_b32 v225, 0
    v_mov_b32 v226, 0
    v_mov_b32 v227, 0
    v_mov_b32 v228, 0
    v_mov_b32 v229, 0
    v_mov_b32 v230, 0
    v_mov_b32 v231, 0
    v_mov_b32 v232, 0
    v_mov_b32 v233, 0
    v_mov_b32 v234, 0
    v_mov_b32 v235, 0
    v_mov_b32 v236, 0
    v_mov_b32 v237, 0
    v_mov_b32 v238, 0
    v_mov_b32 v239, 0
    v_mov_b32 v240, 0
    v_mov_b32 v241, 0
    v_mov_b32 v242, 0
    v_mov_b32 v243, 0
    v_mov_b32 v244, 0
    v_mov_b32 v245, 0
    v_mov_b32 v246, 0
    v_mov_b32 v247, 0
    v_mov_b32 v248, 0
    v_mov_b32 v249, 0
    v_mov_b32 v250, 0
    v_mov_b32 v251, 0
    v_mov_b32 v252, 0
    v_mov_b32 v253, 0
    v_mov_b32 v254, 0
    v_mov_b32 v255, 0
    v_mov_b32 v20, 0xff61b1e6
    v_mov_b32 v21, 0
    s_cmp_lg_u32 s3, 1
    s_cbranch_scc1 LA_qbar
    s_lshr_b32 s63, s2, 3
    s_and_b32 s63, s63, 3
    s_lshl_b32 s63, s63, 6
LA_poll:
    s_mov_b32 s65, 0
    s_atomic_add s65, s[52:53], s63 glc
    s_waitcnt lgkmcnt(0)
    s_cmp_ge_u32 s65, 32
    s_cbranch_scc1 LA_pdone
    s_sleep 16
    s_branch LA_poll
LA_pdone:
LA_qbar:
    s_barrier
    s_lshl_b32 s63, s59, 10
    s_add_u32 s63, s63, 1179648
    buffer_load_dwordx4 v[64:67], v27, s[28:31], s63 offen offset:0 sc1
    buffer_load_dwordx4 v[68:71], v27, s[28:31], s63 offen offset:64 sc1
    buffer_load_dwordx4 v[72:75], v27, s[28:31], s63 offen offset:128 sc1
    buffer_load_dwordx4 v[76:79], v27, s[28:31], s63 offen offset:192 sc1
    buffer_load_dwordx4 v[80:83], v27, s[28:31], s63 offen offset:256 sc1
    buffer_load_dwordx4 v[84:87], v27, s[28:31], s63 offen offset:320 sc1
    buffer_load_dwordx4 v[88:91], v27, s[28:31], s63 offen offset:384 sc1
    buffer_load_dwordx4 v[92:95], v27, s[28:31], s63 offen offset:448 sc1
    s_mov_b32 s75, 2
    s_cmp_lt_u32 s75, 12
    s_cbranch_scc1 LA_st1
    s_mov_b32 s64, 1
    s_atomic_add s64, s[54:55], s57 glc
    s_branch LA_sd1
LA_st1:
    s_lshl_b32 s64, s75, 3
    s_add_u32 s64, s64, s58
    s_sub_u32 s64, s64, 96
LA_sd1:
    s_add_u32 s75, s75, 1
    s_waitcnt vmcnt(0)
LA_loop:
    ds_read_b128 v[96:99], v8 offset:0
    ds_read_b128 v[100:103], v9 offset:0
    ds_read_b128 v[104:107], v10 offset:0
    ds_read_b128 v[108:111], v11 offset:0
    ds_read_b128 v[112:115], v8 offset:256
    ds_read_b128 v[116:119], v9 offset:256
    ds_read_b128 v[120:123], v10 offset:256
    ds_read_b128 v[124:127], v11 offset:256
    s_waitcnt lgkmcnt(0)
    s_add_u32 s64, s64, 96
    s_lshl_b32 s63, s64, 14
    s_add_u32 s61, s56, s63
    s_cmp_ge_u32 s64, 128
    s_cbranch_scc1 LA_last
    s_waitcnt vmcnt(24)
    ds_write_b128 v31, a[0:3] offset:0
    ds_write_b128 v31, a[4:7] offset:1024
    ds_write_b128 v31, a[8:11] offset:2048
    ds_write_b128 v31, a[12:15] offset:3072
    ds_write_b128 v31, a[16:19] offset:4096
    ds_write_b128 v31, a[20:23] offset:5120
    ds_write_b128 v31, a[24:27] offset:6144
    ds_write_b128 v31, a[28:31] offset:7168
    s_waitcnt lgkmcnt(0)
    s_add_u32 s63, s61, 0
    buffer_load_dwordx4 a[0:3], v4, s[8:11], s63 offen offset:0 nt
    buffer_load_dwordx4 a[4:7], v5, s[8:11], s63 offen offset:1024 nt
    buffer_load_dwordx4 a[8:11], v6, s[8:11], s63 offen offset:2048 nt
    buffer_load_dwordx4 a[12:15], v7, s[8:11], s63 offen offset:3072 nt
    s_add_u32 s63, s61, 4096
    buffer_load_dwordx4 a[16:19], v4, s[8:11], s63 offen offset:0 nt
    buffer_load_dwordx4 a[20:23], v5, s[8:11], s63 offen offset:1024 nt
    buffer_load_dwordx4 a[24:27], v6, s[8:11], s63 offen offset:2048 nt
    buffer_load_dwordx4 a[28:31], v7, s[8:11], s63 offen offset:3072 nt
    v_mfma_f32_16x16x32_bf16 v[32:35], v[96:99], v[64:67], 0
    v_mfma_f32_16x16x32_bf16 v[32:35], v[100:103], v[68:71], v[32:35]
    v_mfma_f32_16x16x32_bf16 v[32:35], v[104:107], v[72:75], v[32:35]
    v_mfma_f32_16x16x32_bf16 v[32:35], v[108:111], v[76:79], v[32:35]
    v_mfma_f32_16x16x32_bf16 v[32:35], v[112:115], v[80:83], v[32:35]
    v_mfma_f32_16x16x32_bf16 v[32:35], v[116:119], v[84:87], v[32:35]
    v_mfma_f32_16x16x32_bf16 v[32:35], v[120:123], v[88:91], v[32:35]
    v_mfma_f32_16x16x32_bf16 v[32:35], v[124:127], v[92:95], v[32:35]
    ds_read_b128 v[96:99], v8 offset:8192
    ds_read_b128 v[100:103], v9 offset:8192
    ds_read_b128 v[104:107], v10 offset:8192
    ds_read_b128 v[108:111], v11 offset:8192
    ds_read_b128 v[112:115], v8 offset:8448
    ds_read_b128 v[116:119], v9 offset:8448
    ds_read_b128 v[120:123], v10 offset:8448
    ds_read_b128 v[124:127], v11 offset:8448
    s_waitcnt lgkmcnt(0)
    s_waitcnt vmcnt(24)
    ds_write_b128 v31, a[32:35] offset:8192
    ds_write_b128 v31, a[36:39] offset:9216
    ds_write_b128 v31, a[40:43] offset:10240
    ds_write_b128 v31, a[44:47] offset:11264
    ds_write_b128 v31, a[48:51] offset:12288
    ds_write_b128 v31, a[52:55] offset:13312
    ds_write_b128 v31, a[56:59] offset:14336
    ds_write_b128 v31, a[60:63] offset:15360
    s_waitcnt lgkmcnt(0)
    s_add_u32 s63, s61, 8192
    buffer_load_dwordx4 a[32:35], v4, s[8:11], s63 offen offset:0 nt
    buffer_load_dwordx4 a[36:39], v5, s[8:11], s63 offen offset:1024 nt
    buffer_load_dwordx4 a[40:43], v6, s[8:11], s63 offen offset:2048 nt
    buffer_load_dwordx4 a[44:47], v7, s[8:11], s63 offen offset:3072 nt
    s_add_u32 s63, s61, 12288
    buffer_load_dwordx4 a[48:51], v4, s[8:11], s63 offen offset:0 nt
    buffer_load_dwordx4 a[52:55], v5, s[8:11], s63 offen offset:1024 nt
    buffer_load_dwordx4 a[56:59], v6, s[8:11], s63 offen offset:2048 nt
    buffer_load_dwordx4 a[60:63], v7, s[8:11], s63 offen offset:3072 nt
    v_mfma_f32_16x16x32_bf16 v[36:39], v[96:99], v[64:67], 0
    v_mfma_f32_16x16x32_bf16 v[36:39], v[100:103], v[68:71], v[36:39]
    v_mfma_f32_16x16x32_bf16 v[36:39], v[104:107], v[72:75], v[36:39]
    v_mfma_f32_16x16x32_bf16 v[36:39], v[108:111], v[76:79], v[36:39]
    v_mfma_f32_16x16x32_bf16 v[36:39], v[112:115], v[80:83], v[36:39]
    v_mfma_f32_16x16x32_bf16 v[36:39], v[116:119], v[84:87], v[36:39]
    v_mfma_f32_16x16x32_bf16 v[36:39], v[120:123], v[88:91], v[36:39]
    v_mfma_f32_16x16x32_bf16 v[36:39], v[124:127], v[92:95], v[36:39]
    s_nop 7
    v_cvt_pk_bf16_f32 v40, v32, v33
    v_cvt_pk_bf16_f32 v41, v34, v35
    v_cvt_pk_bf16_f32 v42, v36, v37
    v_cvt_pk_bf16_f32 v43, v38, v39
    v_lshlrev_b32 v44, 16, v40
    v_and_b32 v45, 0xffff0000, v40
    v_lshlrev_b32 v46, 16, v41
    v_and_b32 v47, 0xffff0000, v41
    v_lshlrev_b32 v48, 16, v42
    v_and_b32 v49, 0xffff0000, v42
    v_lshlrev_b32 v50, 16, v43
    v_and_b32 v51, 0xffff0000, v43
    v_max3_f32 v23, v44, v45, v46
    v_max3_f32 v23, v23, v47, v48
    v_max3_f32 v23, v23, v49, v50
    v_max3_f32 v23, v23, v51, v20
    v_mov_b32 v24, v23
    s_nop 1
    v_permlane16_swap_b32 v23, v24
    v_max_f32 v23, v23, v24
    v_mov_b32 v24, v23
    s_nop 1
    v_permlane32_swap_b32 v23, v24
    v_max_f32 v23, v23, v24
    v_sub_f32 v24, v20, v23
    v_mul_f32 v24, s74, v24
    v_exp_f32 v22, v24
    v_mov_b32 v20, v23
    v_sub_f32 v44, v44, v23
    v_mul_f32 v44, s74, v44
    v_sub_f32 v45, v45, v23
    v_mul_f32 v45, s74, v45
    v_sub_f32 v46, v46, v23
    v_mul_f32 v46, s74, v46
    v_sub_f32 v47, v47, v23
    v_mul_f32 v47, s74, v47
    v_sub_f32 v48, v48, v23
    v_mul_f32 v48, s74, v48
    v_sub_f32 v49, v49, v23
    v_mul_f32 v49, s74, v49
    v_sub_f32 v50, v50, v23
    v_mul_f32 v50, s74, v50
    v_sub_f32 v51, v51, v23
    v_mul_f32 v51, s74, v51
    v_exp_f32 v44, v44
    v_exp_f32 v45, v45
    v_exp_f32 v46, v46
    v_exp_f32 v47, v47
    v_exp_f32 v48, v48
    v_exp_f32 v49, v49
    v_exp_f32 v50, v50
    v_exp_f32 v51, v51
    v_readlane_b32 s65, v22, 0
    v_readlane_b32 s66, v22, 1
    v_mul_f32 v21, v21, v22
    v_cvt_pk_bf16_f32 v40, v44, v45
    v_cvt_pk_bf16_f32 v41, v46, v47
    v_cvt_pk_bf16_f32 v42, v48, v49
    v_cvt_pk_bf16_f32 v43, v50, v51
    v_add_f32 v24, v44, v45
    v_add_f32 v25, v46, v47
    v_add_f32 v26, v48, v49
    v_add_f32 v27, v50, v51
    v_add_f32 v24, v24, v25
    v_add_f32 v26, v26, v27
    v_add_f32 v24, v24, v26
    v_add_f32 v21, v21, v24
    v_mul_f32 v192, s65, v192
    v_mul_f32 v193, s66, v193
    v_mul_f32 v196, s65, v196
    v_mul_f32 v197, s66, v197
    v_mul_f32 v200, s65, v200
    v_mul_f32 v201, s66, v201
    v_mul_f32 v204, s65, v204
    v_mul_f32 v205, s66, v205
    v_mul_f32 v208, s65, v208
    v_mul_f32 v209, s66, v209
    v_mul_f32 v212, s65, v212
    v_mul_f32 v213, s66, v213
    v_mul_f32 v216, s65, v216
    v_mul_f32 v217, s66, v217
    v_mul_f32 v220, s65, v220
    v_mul_f32 v221, s66, v221
    v_mul_f32 v224, s65, v224
    v_mul_f32 v225, s66, v225
    v_mul_f32 v228, s65, v228
    v_mul_f32 v229, s66, v229
    v_mul_f32 v232, s65, v232
    v_mul_f32 v233, s66, v233
    v_mul_f32 v236, s65, v236
    v_mul_f32 v237, s66, v237
    v_mul_f32 v240, s65, v240
    v_mul_f32 v241, s66, v241
    v_mul_f32 v244, s65, v244
    v_mul_f32 v245, s66, v245
    v_mul_f32 v248, s65, v248
    v_mul_f32 v249, s66, v249
    v_mul_f32 v252, s65, v252
    v_mul_f32 v253, s66, v253
    ds_read_b64_tr_b16 v[128:129], v12 offset:0
    ds_read_b64_tr_b16 v[130:131], v12 offset:8192
    ds_read_b64_tr_b16 v[132:133], v13 offset:0
    ds_read_b64_tr_b16 v[134:135], v13 offset:8192
    ds_read_b64_tr_b16 v[136:137], v14 offset:0
    ds_read_b64_tr_b16 v[138:139], v14 offset:8192
    ds_read_b64_tr_b16 v[140:141], v15 offset:0
    ds_read_b64_tr_b16 v[142:143], v15 offset:8192
    ds_read_b64_tr_b16 v[144:145], v16 offset:0
    ds_read_b64_tr_b16 v[146:147], v16 offset:8192
    ds_read_b64_tr_b16 v[148:149], v17 offset:0
    ds_read_b64_tr_b16 v[150:151], v17 offset:8192
    ds_read_b64_tr_b16 v[152:153], v18 offset:0
    ds_read_b64_tr_b16 v[154:155], v18 offset:8192
    ds_read_b64_tr_b16 v[156:157], v19 offset:0
    ds_read_b64_tr_b16 v[158:159], v19 offset:8192
    ds_read_b64_tr_b16 v[160:161], v12 offset:256
    ds_read_b64_tr_b16 v[162:163], v12 offset:8448
    ds_read_b64_tr_b16 v[164:165], v13 offset:256
    ds_read_b64_tr_b16 v[166:167], v13 offset:8448
    ds_read_b64_tr_b16 v[168:169], v14 offset:256
    ds_read_b64_tr_b16 v[170:171], v14 offset:8448
    ds_read_b64_tr_b16 v[172:173], v15 offset:256
    ds_read_b64_tr_b16 v[174:175], v15 offset:8448
    ds_read_b64_tr_b16 v[176:177], v16 offset:256
    ds_read_b64_tr_b16 v[178:179], v16 offset:8448
    ds_read_b64_tr_b16 v[180:181], v17 offset:256
    ds_read_b64_tr_b16 v[182:183], v17 offset:8448
    ds_read_b64_tr_b16 v[184:185], v18 offset:256
    ds_read_b64_tr_b16 v[186:187], v18 offset:8448
    ds_read_b64_tr_b16 v[188:189], v19 offset:256
    ds_read_b64_tr_b16 v[190:191], v19 offset:8448
    s_waitcnt lgkmcnt(0)
    v_mfma_f32_16x16x32_bf16 v[192:195], v[40:43], v[128:131], v[192:195]
    v_mfma_f32_16x16x32_bf16 v[196:199], v[40:43], v[132:135], v[196:199]
    v_mfma_f32_16x16x32_bf16 v[200:203], v[40:43], v[136:139], v[200:203]
    v_mfma_f32_16x16x32_bf16 v[204:207], v[40:43], v[140:143], v[204:207]
    v_mfma_f32_16x16x32_bf16 v[208:211], v[40:43], v[144:147], v[208:211]
    v_mfma_f32_16x16x32_bf16 v[212:215], v[40:43], v[148:151], v[212:215]
    v_mfma_f32_16x16x32_bf16 v[216:219], v[40:43], v[152:155], v[216:219]
    v_mfma_f32_16x16x32_bf16 v[220:223], v[40:43], v[156:159], v[220:223]
    v_mfma_f32_16x16x32_bf16 v[224:227], v[40:43], v[160:163], v[224:227]
    v_mfma_f32_16x16x32_bf16 v[228:231], v[40:43], v[164:167], v[228:231]
    v_mfma_f32_16x16x32_bf16 v[232:235], v[40:43], v[168:171], v[232:235]
    v_mfma_f32_16x16x32_bf16 v[236:239], v[40:43], v[172:175], v[236:239]
    v_mfma_f32_16x16x32_bf16 v[240:243], v[40:43], v[176:179], v[240:243]
    v_mfma_f32_16x16x32_bf16 v[244:247], v[40:43], v[180:183], v[244:247]
    v_mfma_f32_16x16x32_bf16 v[248:251], v[40:43], v[184:187], v[248:251]
    v_mfma_f32_16x16x32_bf16 v[252:255], v[40:43], v[188:191], v[252:255]
    s_waitcnt vmcnt(16)
    ds_write_b128 v31, a[64:67] offset:16384
    ds_write_b128 v31, a[68:71] offset:17408
    ds_write_b128 v31, a[72:75] offset:18432
    ds_write_b128 v31, a[76:79] offset:19456
    ds_write_b128 v31, a[80:83] offset:20480
    ds_write_b128 v31, a[84:87] offset:21504
    ds_write_b128 v31, a[88:91] offset:22528
    ds_write_b128 v31, a[92:95] offset:23552
    ds_write_b128 v31, a[96:99] offset:24576
    ds_write_b128 v31, a[100:103] offset:25600
    ds_write_b128 v31, a[104:107] offset:26624
    ds_write_b128 v31, a[108:111] offset:27648
    ds_write_b128 v31, a[112:115] offset:28672
    ds_write_b128 v31, a[116:119] offset:29696
    ds_write_b128 v31, a[120:123] offset:30720
    ds_write_b128 v31, a[124:127] offset:31744
    s_waitcnt lgkmcnt(0)
    s_add_u32 s63, s61, 0
    buffer_load_dwordx4 a[64:67], v4, s[12:15], s63 offen offset:0 nt
    buffer_load_dwordx4 a[68:71], v5, s[12:15], s63 offen offset:1024 nt
    buffer_load_dwordx4 a[72:75], v6, s[12:15], s63 offen offset:2048 nt
    buffer_load_dwordx4 a[76:79], v7, s[12:15], s63 offen offset:3072 nt
    s_add_u32 s63, s61, 4096
    buffer_load_dwordx4 a[80:83], v4, s[12:15], s63 offen offset:0 nt
    buffer_load_dwordx4 a[84:87], v5, s[12:15], s63 offen offset:1024 nt
    buffer_load_dwordx4 a[88:91], v6, s[12:15], s63 offen offset:2048 nt
    buffer_load_dwordx4 a[92:95], v7, s[12:15], s63 offen offset:3072 nt
    s_add_u32 s63, s61, 8192
    buffer_load_dwordx4 a[96:99], v4, s[12:15], s63 offen offset:0 nt
    buffer_load_dwordx4 a[100:103], v5, s[12:15], s63 offen offset:1024 nt
    buffer_load_dwordx4 a[104:107], v6, s[12:15], s63 offen offset:2048 nt
    buffer_load_dwordx4 a[108:111], v7, s[12:15], s63 offen offset:3072 nt
    s_add_u32 s63, s61, 12288
    buffer_load_dwordx4 a[112:115], v4, s[12:15], s63 offen offset:0 nt
    buffer_load_dwordx4 a[116:119], v5, s[12:15], s63 offen offset:1024 nt
    buffer_load_dwordx4 a[120:123], v6, s[12:15], s63 offen offset:2048 nt
    buffer_load_dwordx4 a[124:127], v7, s[12:15], s63 offen offset:3072 nt
    s_cmp_lt_u32 s75, 12
    s_cbranch_scc1 LA_st2
    s_mov_b32 s64, 1
    s_atomic_add s64, s[54:55], s57 glc
    s_branch LA_sd2
LA_st2:
    s_lshl_b32 s64, s75, 3
    s_add_u32 s64, s64, s58
    s_sub_u32 s64, s64, 96
LA_sd2:
    s_add_u32 s75, s75, 1
    s_branch LA_loop
LA_last:
    s_waitcnt vmcnt(24)
    ds_write_b128 v31, a[0:3] offset:0
    ds_write_b128 v31, a[4:7] offset:1024
    ds_write_b128 v31, a[8:11] offset:2048
    ds_write_b128 v31, a[12:15] offset:3072
    ds_write_b128 v31, a[16:19] offset:4096
    ds_write_b128 v31, a[20:23] offset:5120
    ds_write_b128 v31, a[24:27] offset:6144
    ds_write_b128 v31, a[28:31] offset:7168
    s_waitcnt lgkmcnt(0)
    v_mfma_f32_16x16x32_bf16 v[32:35], v[96:99], v[64:67], 0
    v_mfma_f32_16x16x32_bf16 v[32:35], v[100:103], v[68:71], v[32:35]
    v_mfma_f32_16x16x32_bf16 v[32:35], v[104:107], v[72:75], v[32:35]
    v_mfma_f32_16x16x32_bf16 v[32:35], v[108:111], v[76:79], v[32:35]
    v_mfma_f32_16x16x32_bf16 v[32:35], v[112:115], v[80:83], v[32:35]
    v_mfma_f32_16x16x32_bf16 v[32:35], v[116:119], v[84:87], v[32:35]
    v_mfma_f32_16x16x32_bf16 v[32:35], v[120:123], v[88:91], v[32:35]
    v_mfma_f32_16x16x32_bf16 v[32:35], v[124:127], v[92:95], v[32:35]
    ds_read_b128 v[96:99], v8 offset:8192
    ds_read_b128 v[100:103], v9 offset:8192
    ds_read_b128 v[104:107], v10 offset:8192
    ds_read_b128 v[108:111], v11 offset:8192
    ds_read_b128 v[112:115], v8 offset:8448
    ds_read_b128 v[116:119], v9 offset:8448
    ds_read_b128 v[120:123], v10 offset:8448
    ds_read_b128 v[124:127], v11 offset:8448
    s_waitcnt lgkmcnt(0)
    s_waitcnt vmcnt(16)
    ds_write_b128 v31, a[32:35] offset:8192
    ds_write_b128 v31, a[36:39] offset:9216
    ds_write_b128 v31, a[40:43] offset:10240
    ds_write_b128 v31, a[44:47] offset:11264
    ds_write_b128 v31, a[48:51] offset:12288
    ds_write_b128 v31, a[52:55] offset:13312
    ds_write_b128 v31, a[56:59] offset:14336
    ds_write_b128 v31, a[60:63] offset:15360
    s_waitcnt lgkmcnt(0)
    v_mfma_f32_16x16x32_bf16 v[36:39], v[96:99], v[64:67], 0
    v_mfma_f32_16x16x32_bf16 v[36:39], v[100:103], v[68:71], v[36:39]
    v_mfma_f32_16x16x32_bf16 v[36:39], v[104:107], v[72:75], v[36:39]
    v_mfma_f32_16x16x32_bf16 v[36:39], v[108:111], v[76:79], v[36:39]
    v_mfma_f32_16x16x32_bf16 v[36:39], v[112:115], v[80:83], v[36:39]
    v_mfma_f32_16x16x32_bf16 v[36:39], v[116:119], v[84:87], v[36:39]
    v_mfma_f32_16x16x32_bf16 v[36:39], v[120:123], v[88:91], v[36:39]
    v_mfma_f32_16x16x32_bf16 v[36:39], v[124:127], v[92:95], v[36:39]
    s_nop 7
    v_cvt_pk_bf16_f32 v40, v32, v33
    v_cvt_pk_bf16_f32 v41, v34, v35
    v_cvt_pk_bf16_f32 v42, v36, v37
    v_cvt_pk_bf16_f32 v43, v38, v39
    v_lshlrev_b32 v44, 16, v40
    v_and_b32 v45, 0xffff0000, v40
    v_lshlrev_b32 v46, 16, v41
    v_and_b32 v47, 0xffff0000, v41
    v_lshlrev_b32 v48, 16, v42
    v_and_b32 v49, 0xffff0000, v42
    v_lshlrev_b32 v50, 16, v43
    v_and_b32 v51, 0xffff0000, v43
    v_max3_f32 v23, v44, v45, v46
    v_max3_f32 v23, v23, v47, v48
    v_max3_f32 v23, v23, v49, v50
    v_max3_f32 v23, v23, v51, v20
    v_mov_b32 v24, v23
    s_nop 1
    v_permlane16_swap_b32 v23, v24
    v_max_f32 v23, v23, v24
    v_mov_b32 v24, v23
    s_nop 1
    v_permlane32_swap_b32 v23, v24
    v_max_f32 v23, v23, v24
    v_sub_f32 v24, v20, v23
    v_mul_f32 v24, s74, v24
    v_exp_f32 v22, v24
    v_mov_b32 v20, v23
    v_sub_f32 v44, v44, v23
    v_mul_f32 v44, s74, v44
    v_sub_f32 v45, v45, v23
    v_mul_f32 v45, s74, v45
    v_sub_f32 v46, v46, v23
    v_mul_f32 v46, s74, v46
    v_sub_f32 v47, v47, v23
    v_mul_f32 v47, s74, v47
    v_sub_f32 v48, v48, v23
    v_mul_f32 v48, s74, v48
    v_sub_f32 v49, v49, v23
    v_mul_f32 v49, s74, v49
    v_sub_f32 v50, v50, v23
    v_mul_f32 v50, s74, v50
    v_sub_f32 v51, v51, v23
    v_mul_f32 v51, s74, v51
    v_exp_f32 v44, v44
    v_exp_f32 v45, v45
    v_exp_f32 v46, v46
    v_exp_f32 v47, v47
    v_exp_f32 v48, v48
    v_exp_f32 v49, v49
    v_exp_f32 v50, v50
    v_exp_f32 v51, v51
    v_readlane_b32 s65, v22, 0
    v_readlane_b32 s66, v22, 1
    v_mul_f32 v21, v21, v22
    v_cvt_pk_bf16_f32 v40, v44, v45
    v_cvt_pk_bf16_f32 v41, v46, v47
    v_cvt_pk_bf16_f32 v42, v48, v49
    v_cvt_pk_bf16_f32 v43, v50, v51
    v_add_f32 v24, v44, v45
    v_add_f32 v25, v46, v47
    v_add_f32 v26, v48, v49
    v_add_f32 v27, v50, v51
    v_add_f32 v24, v24, v25
    v_add_f32 v26, v26, v27
    v_add_f32 v24, v24, v26
    v_add_f32 v21, v21, v24
    v_mul_f32 v192, s65, v192
    v_mul_f32 v193, s66, v193
    v_mul_f32 v196, s65, v196
    v_mul_f32 v197, s66, v197
    v_mul_f32 v200, s65, v200
    v_mul_f32 v201, s66, v201
    v_mul_f32 v204, s65, v204
    v_mul_f32 v205, s66, v205
    v_mul_f32 v208, s65, v208
    v_mul_f32 v209, s66, v209
    v_mul_f32 v212, s65, v212
    v_mul_f32 v213, s66, v213
    v_mul_f32 v216, s65, v216
    v_mul_f32 v217, s66, v217
    v_mul_f32 v220, s65, v220
    v_mul_f32 v221, s66, v221
    v_mul_f32 v224, s65, v224
    v_mul_f32 v225, s66, v225
    v_mul_f32 v228, s65, v228
    v_mul_f32 v229, s66, v229
    v_mul_f32 v232, s65, v232
    v_mul_f32 v233, s66, v233
    v_mul_f32 v236, s65, v236
    v_mul_f32 v237, s66, v237
    v_mul_f32 v240, s65, v240
    v_mul_f32 v241, s66, v241
    v_mul_f32 v244, s65, v244
    v_mul_f32 v245, s66, v245
    v_mul_f32 v248, s65, v248
    v_mul_f32 v249, s66, v249
    v_mul_f32 v252, s65, v252
    v_mul_f32 v253, s66, v253
    ds_read_b64_tr_b16 v[128:129], v12 offset:0
    ds_read_b64_tr_b16 v[130:131], v12 offset:8192
    ds_read_b64_tr_b16 v[132:133], v13 offset:0
    ds_read_b64_tr_b16 v[134:135], v13 offset:8192
    ds_read_b64_tr_b16 v[136:137], v14 offset:0
    ds_read_b64_tr_b16 v[138:139], v14 offset:8192
    ds_read_b64_tr_b16 v[140:141], v15 offset:0
    ds_read_b64_tr_b16 v[142:143], v15 offset:8192
    ds_read_b64_tr_b16 v[144:145], v16 offset:0
    ds_read_b64_tr_b16 v[146:147], v16 offset:8192
    ds_read_b64_tr_b16 v[148:149], v17 offset:0
    ds_read_b64_tr_b16 v[150:151], v17 offset:8192
    ds_read_b64_tr_b16 v[152:153], v18 offset:0
    ds_read_b64_tr_b16 v[154:155], v18 offset:8192
    ds_read_b64_tr_b16 v[156:157], v19 offset:0
    ds_read_b64_tr_b16 v[158:159], v19 offset:8192
    ds_read_b64_tr_b16 v[160:161], v12 offset:256
    ds_read_b64_tr_b16 v[162:163], v12 offset:8448
    ds_read_b64_tr_b16 v[164:165], v13 offset:256
    ds_read_b64_tr_b16 v[166:167], v13 offset:8448
    ds_read_b64_tr_b16 v[168:169], v14 offset:256
    ds_read_b64_tr_b16 v[170:171], v14 offset:8448
    ds_read_b64_tr_b16 v[172:173], v15 offset:256
    ds_read_b64_tr_b16 v[174:175], v15 offset:8448
    ds_read_b64_tr_b16 v[176:177], v16 offset:256
    ds_read_b64_tr_b16 v[178:179], v16 offset:8448
    ds_read_b64_tr_b16 v[180:181], v17 offset:256
    ds_read_b64_tr_b16 v[182:183], v17 offset:8448
    ds_read_b64_tr_b16 v[184:185], v18 offset:256
    ds_read_b64_tr_b16 v[186:187], v18 offset:8448
    ds_read_b64_tr_b16 v[188:189], v19 offset:256
    ds_read_b64_tr_b16 v[190:191], v19 offset:8448
    s_waitcnt lgkmcnt(0)
    v_mfma_f32_16x16x32_bf16 v[192:195], v[40:43], v[128:131], v[192:195]
    v_mfma_f32_16x16x32_bf16 v[196:199], v[40:43], v[132:135], v[196:199]
    v_mfma_f32_16x16x32_bf16 v[200:203], v[40:43], v[136:139], v[200:203]
    v_mfma_f32_16x16x32_bf16 v[204:207], v[40:43], v[140:143], v[204:207]
    v_mfma_f32_16x16x32_bf16 v[208:211], v[40:43], v[144:147], v[208:211]
    v_mfma_f32_16x16x32_bf16 v[212:215], v[40:43], v[148:151], v[212:215]
    v_mfma_f32_16x16x32_bf16 v[216:219], v[40:43], v[152:155], v[216:219]
    v_mfma_f32_16x16x32_bf16 v[220:223], v[40:43], v[156:159], v[220:223]
    v_mfma_f32_16x16x32_bf16 v[224:227], v[40:43], v[160:163], v[224:227]
    v_mfma_f32_16x16x32_bf16 v[228:231], v[40:43], v[164:167], v[228:231]
    v_mfma_f32_16x16x32_bf16 v[232:235], v[40:43], v[168:171], v[232:235]
    v_mfma_f32_16x16x32_bf16 v[236:239], v[40:43], v[172:175], v[236:239]
    v_mfma_f32_16x16x32_bf16 v[240:243], v[40:43], v[176:179], v[240:243]
    v_mfma_f32_16x16x32_bf16 v[244:247], v[40:43], v[180:183], v[244:247]
    v_mfma_f32_16x16x32_bf16 v[248:251], v[40:43], v[184:187], v[248:251]
    v_mfma_f32_16x16x32_bf16 v[252:255], v[40:43], v[188:191], v[252:255]
    s_waitcnt vmcnt(0)
    ds_write_b128 v31, a[64:67] offset:16384
    ds_write_b128 v31, a[68:71] offset:17408
    ds_write_b128 v31, a[72:75] offset:18432
    ds_write_b128 v31, a[76:79] offset:19456
    ds_write_b128 v31, a[80:83] offset:20480
    ds_write_b128 v31, a[84:87] offset:21504
    ds_write_b128 v31, a[88:91] offset:22528
    ds_write_b128 v31, a[92:95] offset:23552
    ds_write_b128 v31, a[96:99] offset:24576
    ds_write_b128 v31, a[100:103] offset:25600
    ds_write_b128 v31, a[104:107] offset:26624
    ds_write_b128 v31, a[108:111] offset:27648
    ds_write_b128 v31, a[112:115] offset:28672
    ds_write_b128 v31, a[116:119] offset:29696
    ds_write_b128 v31, a[120:123] offset:30720
    ds_write_b128 v31, a[124:127] offset:31744
    s_waitcnt lgkmcnt(0)
    ds_read_b128 v[96:99], v8 offset:0
    ds_read_b128 v[100:103], v9 offset:0
    ds_read_b128 v[104:107], v10 offset:0
    ds_read_b128 v[108:111], v11 offset:0
    ds_read_b128 v[112:115], v8 offset:256
    ds_read_b128 v[116:119], v9 offset:256
    ds_read_b128 v[120:123], v10 offset:256
    ds_read_b128 v[124:127], v11 offset:256
    s_waitcnt lgkmcnt(0)
    v_mfma_f32_16x16x32_bf16 v[32:35], v[96:99], v[64:67], 0
    v_mfma_f32_16x16x32_bf16 v[32:35], v[100:103], v[68:71], v[32:35]
    v_mfma_f32_16x16x32_bf16 v[32:35], v[104:107], v[72:75], v[32:35]
    v_mfma_f32_16x16x32_bf16 v[32:35], v[108:111], v[76:79], v[32:35]
    v_mfma_f32_16x16x32_bf16 v[32:35], v[112:115], v[80:83], v[32:35]
    v_mfma_f32_16x16x32_bf16 v[32:35], v[116:119], v[84:87], v[32:35]
    v_mfma_f32_16x16x32_bf16 v[32:35], v[120:123], v[88:91], v[32:35]
    v_mfma_f32_16x16x32_bf16 v[32:35], v[124:127], v[92:95], v[32:35]
    ds_read_b128 v[96:99], v8 offset:8192
    ds_read_b128 v[100:103], v9 offset:8192
    ds_read_b128 v[104:107], v10 offset:8192
    ds_read_b128 v[108:111], v11 offset:8192
    ds_read_b128 v[112:115], v8 offset:8448
    ds_read_b128 v[116:119], v9 offset:8448
    ds_read_b128 v[120:123], v10 offset:8448
    ds_read_b128 v[124:127], v11 offset:8448
    s_waitcnt lgkmcnt(0)
    v_mfma_f32_16x16x32_bf16 v[36:39], v[96:99], v[64:67], 0
    v_mfma_f32_16x16x32_bf16 v[36:39], v[100:103], v[68:71], v[36:39]
    v_mfma_f32_16x16x32_bf16 v[36:39], v[104:107], v[72:75], v[36:39]
    v_mfma_f32_16x16x32_bf16 v[36:39], v[108:111], v[76:79], v[36:39]
    v_mfma_f32_16x16x32_bf16 v[36:39], v[112:115], v[80:83], v[36:39]
    v_mfma_f32_16x16x32_bf16 v[36:39], v[116:119], v[84:87], v[36:39]
    v_mfma_f32_16x16x32_bf16 v[36:39], v[120:123], v[88:91], v[36:39]
    v_mfma_f32_16x16x32_bf16 v[36:39], v[124:127], v[92:95], v[36:39]
    s_nop 7
    v_cvt_pk_bf16_f32 v40, v32, v33
    v_cvt_pk_bf16_f32 v41, v34, v35
    v_cvt_pk_bf16_f32 v42, v36, v37
    v_cvt_pk_bf16_f32 v43, v38, v39
    v_lshlrev_b32 v44, 16, v40
    v_and_b32 v45, 0xffff0000, v40
    v_lshlrev_b32 v46, 16, v41
    v_and_b32 v47, 0xffff0000, v41
    v_lshlrev_b32 v48, 16, v42
    v_and_b32 v49, 0xffff0000, v42
    v_lshlrev_b32 v50, 16, v43
    v_and_b32 v51, 0xffff0000, v43
    v_max3_f32 v23, v44, v45, v46
    v_max3_f32 v23, v23, v47, v48
    v_max3_f32 v23, v23, v49, v50
    v_max3_f32 v23, v23, v51, v20
    v_mov_b32 v24, v23
    s_nop 1
    v_permlane16_swap_b32 v23, v24
    v_max_f32 v23, v23, v24
    v_mov_b32 v24, v23
    s_nop 1
    v_permlane32_swap_b32 v23, v24
    v_max_f32 v23, v23, v24
    v_sub_f32 v24, v20, v23
    v_mul_f32 v24, s74, v24
    v_exp_f32 v22, v24
    v_mov_b32 v20, v23
    v_sub_f32 v44, v44, v23
    v_mul_f32 v44, s74, v44
    v_sub_f32 v45, v45, v23
    v_mul_f32 v45, s74, v45
    v_sub_f32 v46, v46, v23
    v_mul_f32 v46, s74, v46
    v_sub_f32 v47, v47, v23
    v_mul_f32 v47, s74, v47
    v_sub_f32 v48, v48, v23
    v_mul_f32 v48, s74, v48
    v_sub_f32 v49, v49, v23
    v_mul_f32 v49, s74, v49
    v_sub_f32 v50, v50, v23
    v_mul_f32 v50, s74, v50
    v_sub_f32 v51, v51, v23
    v_mul_f32 v51, s74, v51
    v_exp_f32 v44, v44
    v_exp_f32 v45, v45
    v_exp_f32 v46, v46
    v_exp_f32 v47, v47
    v_exp_f32 v48, v48
    v_exp_f32 v49, v49
    v_exp_f32 v50, v50
    v_exp_f32 v51, v51
    v_readlane_b32 s65, v22, 0
    v_readlane_b32 s66, v22, 1
    v_mul_f32 v21, v21, v22
    v_cvt_pk_bf16_f32 v40, v44, v45
    v_cvt_pk_bf16_f32 v41, v46, v47
    v_cvt_pk_bf16_f32 v42, v48, v49
    v_cvt_pk_bf16_f32 v43, v50, v51
    v_add_f32 v24, v44, v45
    v_add_f32 v25, v46, v47
    v_add_f32 v26, v48, v49
    v_add_f32 v27, v50, v51
    v_add_f32 v24, v24, v25
    v_add_f32 v26, v26, v27
    v_add_f32 v24, v24, v26
    v_add_f32 v21, v21, v24
    v_mul_f32 v192, s65, v192
    v_mul_f32 v193, s66, v193
    v_mul_f32 v196, s65, v196
    v_mul_f32 v197, s66, v197
    v_mul_f32 v200, s65, v200
    v_mul_f32 v201, s66, v201
    v_mul_f32 v204, s65, v204
    v_mul_f32 v205, s66, v205
    v_mul_f32 v208, s65, v208
    v_mul_f32 v209, s66, v209
    v_mul_f32 v212, s65, v212
    v_mul_f32 v213, s66, v213
    v_mul_f32 v216, s65, v216
    v_mul_f32 v217, s66, v217
    v_mul_f32 v220, s65, v220
    v_mul_f32 v221, s66, v221
    v_mul_f32 v224, s65, v224
    v_mul_f32 v225, s66, v225
    v_mul_f32 v228, s65, v228
    v_mul_f32 v229, s66, v229
    v_mul_f32 v232, s65, v232
    v_mul_f32 v233, s66, v233
    v_mul_f32 v236, s65, v236
    v_mul_f32 v237, s66, v237
    v_mul_f32 v240, s65, v240
    v_mul_f32 v241, s66, v241
    v_mul_f32 v244, s65, v244
    v_mul_f32 v245, s66, v245
    v_mul_f32 v248, s65, v248
    v_mul_f32 v249, s66, v249
    v_mul_f32 v252, s65, v252
    v_mul_f32 v253, s66, v253
    ds_read_b64_tr_b16 v[128:129], v12 offset:0
    ds_read_b64_tr_b16 v[130:131], v12 offset:8192
    ds_read_b64_tr_b16 v[132:133], v13 offset:0
    ds_read_b64_tr_b16 v[134:135], v13 offset:8192
    ds_read_b64_tr_b16 v[136:137], v14 offset:0
    ds_read_b64_tr_b16 v[138:139], v14 offset:8192
    ds_read_b64_tr_b16 v[140:141], v15 offset:0
    ds_read_b64_tr_b16 v[142:143], v15 offset:8192
    ds_read_b64_tr_b16 v[144:145], v16 offset:0
    ds_read_b64_tr_b16 v[146:147], v16 offset:8192
    ds_read_b64_tr_b16 v[148:149], v17 offset:0
    ds_read_b64_tr_b16 v[150:151], v17 offset:8192
    ds_read_b64_tr_b16 v[152:153], v18 offset:0
    ds_read_b64_tr_b16 v[154:155], v18 offset:8192
    ds_read_b64_tr_b16 v[156:157], v19 offset:0
    ds_read_b64_tr_b16 v[158:159], v19 offset:8192
    ds_read_b64_tr_b16 v[160:161], v12 offset:256
    ds_read_b64_tr_b16 v[162:163], v12 offset:8448
    ds_read_b64_tr_b16 v[164:165], v13 offset:256
    ds_read_b64_tr_b16 v[166:167], v13 offset:8448
    ds_read_b64_tr_b16 v[168:169], v14 offset:256
    ds_read_b64_tr_b16 v[170:171], v14 offset:8448
    ds_read_b64_tr_b16 v[172:173], v15 offset:256
    ds_read_b64_tr_b16 v[174:175], v15 offset:8448
    ds_read_b64_tr_b16 v[176:177], v16 offset:256
    ds_read_b64_tr_b16 v[178:179], v16 offset:8448
    ds_read_b64_tr_b16 v[180:181], v17 offset:256
    ds_read_b64_tr_b16 v[182:183], v17 offset:8448
    ds_read_b64_tr_b16 v[184:185], v18 offset:256
    ds_read_b64_tr_b16 v[186:187], v18 offset:8448
    ds_read_b64_tr_b16 v[188:189], v19 offset:256
    ds_read_b64_tr_b16 v[190:191], v19 offset:8448
    s_waitcnt lgkmcnt(0)
    v_mfma_f32_16x16x32_bf16 v[192:195], v[40:43], v[128:131], v[192:195]
    v_mfma_f32_16x16x32_bf16 v[196:199], v[40:43], v[132:135], v[196:199]
    v_mfma_f32_16x16x32_bf16 v[200:203], v[40:43], v[136:139], v[200:203]
    v_mfma_f32_16x16x32_bf16 v[204:207], v[40:43], v[140:143], v[204:207]
    v_mfma_f32_16x16x32_bf16 v[208:211], v[40:43], v[144:147], v[208:211]
    v_mfma_f32_16x16x32_bf16 v[212:215], v[40:43], v[148:151], v[212:215]
    v_mfma_f32_16x16x32_bf16 v[216:219], v[40:43], v[152:155], v[216:219]
    v_mfma_f32_16x16x32_bf16 v[220:223], v[40:43], v[156:159], v[220:223]
    v_mfma_f32_16x16x32_bf16 v[224:227], v[40:43], v[160:163], v[224:227]
    v_mfma_f32_16x16x32_bf16 v[228:231], v[40:43], v[164:167], v[228:231]
    v_mfma_f32_16x16x32_bf16 v[232:235], v[40:43], v[168:171], v[232:235]
    v_mfma_f32_16x16x32_bf16 v[236:239], v[40:43], v[172:175], v[236:239]
    v_mfma_f32_16x16x32_bf16 v[240:243], v[40:43], v[176:179], v[240:243]
    v_mfma_f32_16x16x32_bf16 v[244:247], v[40:43], v[180:183], v[244:247]
    v_mfma_f32_16x16x32_bf16 v[248:251], v[40:43], v[184:187], v[248:251]
    v_mfma_f32_16x16x32_bf16 v[252:255], v[40:43], v[188:191], v[252:255]
    v_mov_b32 v24, v21
    s_nop 1
    v_permlane16_swap_b32 v21, v24
    v_add_f32 v21, v21, v24
    v_mov_b32 v24, v21
    s_nop 1
    v_permlane32_swap_b32 v21, v24
    v_add_f32 v21, v21, v24
    s_nop 7
    s_lshl_b32 s63, s3, 11
    v_lshlrev_b32 v23, 2, v1
    v_add_u32 v23, s63, v23
    v_cmp_gt_u32 vcc, 16, v1
    s_and_saveexec_b64 s[76:77], vcc
    ds_write_b32 v23, v192 offset:0
    ds_write_b32 v23, v193 offset:1024
    ds_write_b32 v23, v196 offset:64
    ds_write_b32 v23, v197 offset:1088
    ds_write_b32 v23, v200 offset:128
    ds_write_b32 v23, v201 offset:1152
    ds_write_b32 v23, v204 offset:192
    ds_write_b32 v23, v205 offset:1216
    ds_write_b32 v23, v208 offset:256
    ds_write_b32 v23, v209 offset:1280
    ds_write_b32 v23, v212 offset:320
    ds_write_b32 v23, v213 offset:1344
    ds_write_b32 v23, v216 offset:384
    ds_write_b32 v23, v217 offset:1408
    ds_write_b32 v23, v220 offset:448
    ds_write_b32 v23, v221 offset:1472
    ds_write_b32 v23, v224 offset:512
    ds_write_b32 v23, v225 offset:1536
    ds_write_b32 v23, v228 offset:576
    ds_write_b32 v23, v229 offset:1600
    ds_write_b32 v23, v232 offset:640
    ds_write_b32 v23, v233 offset:1664
    ds_write_b32 v23, v236 offset:704
    ds_write_b32 v23, v237 offset:1728
    ds_write_b32 v23, v240 offset:768
    ds_write_b32 v23, v241 offset:1792
    ds_write_b32 v23, v244 offset:832
    ds_write_b32 v23, v245 offset:1856
    ds_write_b32 v23, v248 offset:896
    ds_write_b32 v23, v249 offset:1920
    ds_write_b32 v23, v252 offset:960
    ds_write_b32 v23, v253 offset:1984
    s_mov_b64 exec, s[76:77]
    s_lshl_b32 s63, s3, 4
    v_lshlrev_b32 v23, 3, v1
    v_add_u32 v23, s63, v23
    v_cmp_gt_u32 vcc, 2, v1
    s_and_saveexec_b64 s[76:77], vcc
    ds_write_b64 v23, v[20:21] offset:8192
    s_mov_b64 exec, s[76:77]
    s_waitcnt lgkmcnt(0)
    s_barrier
    s_and_b32 s63, s3, 2
    s_lshl_b32 s65, s63, 11
    s_lshl_b32 s66, s60, 10
    s_add_u32 s65, s65, s66
    v_lshlrev_b32 v25, 4, v1
    v_add_u32 v26, s65, v25
    s_lshl_b32 s65, s63, 4
    s_lshl_b32 s66, s60, 3
    s_add_u32 s65, s65, s66
    v_mov_b32 v27, s65
    ds_read_b64 v[32:33], v27 offset:8192
    ds_read_b64 v[34:35], v27 offset:8208
    ds_read_b128 v[40:43], v26 offset:0
    ds_read_b128 v[44:47], v26 offset:2048
    s_waitcnt lgkmcnt(0)
    v_max_f32 v50, v32, v34
    v_sub_f32 v32, v32, v50
    v_sub_f32 v34, v34, v50
    v_mul_f32 v32, s74, v32
    v_mul_f32 v34, s74, v34
    v_exp_f32 v32, v32
    v_exp_f32 v34, v34
    s_nop 0
    v_mul_f32 v51, v32, v33
    v_fmac_f32 v51, v34, v35
    v_mul_f32 v40, v32, v40
    v_fmac_f32 v40, v34, v44
    v_mul_f32 v41, v32, v41
    v_fmac_f32 v41, v34, v45
    v_mul_f32 v42, v32, v42
    v_fmac_f32 v42, v34, v46
    v_mul_f32 v43, v32, v43
    v_fmac_f32 v43, v34, v47
    s_and_b32 s63, s59, 7
    s_lshl_b32 s63, s63, 1
    s_add_u32 s63, s63, s60
    s_lshr_b32 s65, s59, 3
    s_lshl_b32 s65, s65, 3
    s_add_u32 s65, s65, s58
    s_lshl_b32 s79, s63, 16
    s_lshl_b32 s66, s58, 10
    s_add_u32 s79, s79, s66
    s_lshr_b32 s66, s59, 3
    s_lshl_b32 s66, s66, 6
    s_add_u32 s79, s79, s66
    v_lshrrev_b32 v25, 3, v1
    v_and_b32 v26, 3, v1
    v_lshlrev_b32 v26, 4, v26
    v_lshl_add_u32 v25, v25, 13, v26
    v_bfe_u32 v26, v1, 2, 1
    v_lshl_add_u32 v25, v26, 9, v25
    buffer_store_dwordx4 v[40:43], v25, s[28:31], s79 offen
    s_lshl_b32 s79, s63, 9
    s_lshl_b32 s66, s65, 3
    s_add_u32 s79, s79, s66
    s_add_u32 s79, s79, 1048576
    v_mov_b32 v25, 0
    s_mov_b64 exec, 1
    buffer_store_dwordx2 v[50:51], v25, s[28:31], s79 offen
LA_done:
    s_endpgm
    .p2align 8
proj_kernel:
    s_cmp_ge_u32 s2, 184
    s_cbranch_scc1 LB_done
    s_load_dwordx2 s[36:37], s[0:1], 32
    s_load_dwordx2 s[38:39], s[0:1], 64
    s_load_dwordx2 s[40:41], s[0:1], 96
    v_lshrrev_b32 v2, 6, v0
    v_and_b32 v1, 63, v0
    s_nop 0
    v_readfirstlane_b32 s3, v2
    v_lshlrev_b32 v2, 4, v1
    v_and_b32 v3, 15, v1
    v_lshrrev_b32 v4, 4, v1
    s_mul_i32 s62, s3, 7168
    s_waitcnt lgkmcnt(0)
    s_mov_b32 s12, s40
    s_mov_b32 s13, s41
    s_mov_b32 s14, 6291456
    s_mov_b32 s15, 0x20000
    s_cmp_ge_u32 s2, 128
    s_cselect_b32 s42, s38, s36
    s_cselect_b32 s43, s39, s37
    s_cselect_b32 s44, 128, 0
    s_sub_u32 s44, s2, s44
    s_mul_i32 s45, s44, 28672
    s_add_u32 s8, s42, s45
    s_addc_u32 s9, s43, 0
    s_mov_b32 s10, 28672
    s_mov_b32 s11, 0x20000
    s_mov_b32 m0, s62
    s_nop 0
    buffer_load_dwordx4 v2, s[8:11], s62 offen offset:0 nt lds
    buffer_load_dwordx4 v2, s[8:11], s62 offen offset:1024 nt lds
    buffer_load_dwordx4 v2, s[8:11], s62 offen offset:2048 nt lds
    buffer_load_dwordx4 v2, s[8:11], s62 offen offset:3072 nt lds
    s_add_u32 s63, s62, 4096
    s_mov_b32 m0, s63
    s_nop 0
    buffer_load_dwordx4 v2, s[8:11], s63 offen offset:0 nt lds
    buffer_load_dwordx4 v2, s[8:11], s63 offen offset:1024 nt lds
    buffer_load_dwordx4 v2, s[8:11], s63 offen offset:2048 nt lds
    v_lshrrev_b32 v5, 2, v1
    v_mul_u32_u24 v5, 896, v5
    v_and_b32 v6, 3, v1
    v_lshl_add_u32 v5, v6, 3, v5
    s_mul_i32 s63, s3, 224
    v_add_u32 v5, s63, v5
    v_mul_u32_u24 v6, 1792, v3
    v_lshl_add_u32 v6, v4, 4, v6
    s_mul_i32 s63, s3, 448
    v_add_u32 v6, s63, v6
    s_cmp_ge_u32 s2, 128
    s_cbranch_scc1 LB_w2
    s_lshl_b32 s46, s2, 13
    s_lshl_b32 s47, s3, 11
    s_add_u32 s46, s46, s47
    s_add_u32 s63, s47, 28672
    s_mov_b32 m0, s63
    s_nop 0
    buffer_load_dwordx4 v2, s[12:15], s46 offen offset:0 lds
    buffer_load_dwordx4 v2, s[12:15], s46 offen offset:1024 lds
    s_cmp_lg_u32 s3, 0
    s_cbranch_scc1 LB_nml
    s_lshr_b32 s46, s2, 3
    s_lshl_b32 s46, s46, 9
    s_add_u32 s46, s46, 1048576
    s_mov_b32 m0, 36864
    s_mov_b64 s[76:77], exec
    s_mov_b32 exec_hi, 0
    buffer_load_dwordx4 v2, s[12:15], s46 offen lds
    s_mov_b64 exec, s[76:77]
LB_nml:
    v_and_b32 v7, 7, v3
    v_lshlrev_b32 v8, 6, v7
    v_lshl_add_u32 v7, v4, 4, v8
    s_mov_b32 s74, 0x3db8aa3b
    s_waitcnt vmcnt(0)
    s_barrier
    ds_read_b128 v[96:99], v8 offset:36864
    ds_read_b128 v[100:103], v8 offset:36880
    ds_read_b128 v[104:107], v8 offset:36896
    ds_read_b128 v[108:111], v8 offset:36912
    ds_read_b128 v[32:35], v7 offset:28672
    ds_read_b128 v[36:39], v7 offset:29184
    ds_read_b128 v[40:43], v7 offset:29696
    ds_read_b128 v[44:47], v7 offset:30208
    ds_read_b128 v[48:51], v7 offset:30720
    ds_read_b128 v[52:55], v7 offset:31232
    ds_read_b128 v[56:59], v7 offset:31744
    ds_read_b128 v[60:63], v7 offset:32256
    ds_read_b128 v[64:67], v7 offset:32768
    ds_read_b128 v[68:71], v7 offset:33280
    ds_read_b128 v[72:75], v7 offset:33792
    ds_read_b128 v[76:79], v7 offset:34304
    ds_read_b128 v[80:83], v7 offset:34816
    ds_read_b128 v[84:87], v7 offset:35328
    ds_read_b128 v[88:91], v7 offset:35840
    ds_read_b128 v[92:95], v7 offset:36352
    s_waitcnt lgkmcnt(15)
    v_max3_f32 v14, v96, v98, v100
    v_max3_f32 v14, v14, v102, v104
    v_max3_f32 v14, v14, v106, v108
    v_max_f32 v14, v14, v110
    v_sub_f32 v96, v96, v14
    v_mul_f32 v96, s74, v96
    v_sub_f32 v98, v98, v14
    v_mul_f32 v98, s74, v98
    v_sub_f32 v100, v100, v14
    v_mul_f32 v100, s74, v100
    v_sub_f32 v102, v102, v14
    v_mul_f32 v102, s74, v102
    v_sub_f32 v104, v104, v14
    v_mul_f32 v104, s74, v104
    v_sub_f32 v106, v106, v14
    v_mul_f32 v106, s74, v106
    v_sub_f32 v108, v108, v14
    v_mul_f32 v108, s74, v108
    v_sub_f32 v110, v110, v14
    v_mul_f32 v110, s74, v110
    v_exp_f32 v96, v96
    v_exp_f32 v98, v98
    v_exp_f32 v100, v100
    v_exp_f32 v102, v102
    v_exp_f32 v104, v104
    v_exp_f32 v106, v106
    v_exp_f32 v108, v108
    v_exp_f32 v110, v110
    s_nop 0
    v_mul_f32 v15, v96, v97
    v_fmac_f32 v15, v98, v99
    v_fmac_f32 v15, v100, v101
    v_fmac_f32 v15, v102, v103
    v_fmac_f32 v15, v104, v105
    v_fmac_f32 v15, v106, v107
    v_fmac_f32 v15, v108, v109
    v_fmac_f32 v15, v110, v111
    v_rcp_f32 v15, v15
    s_nop 0
    v_mul_f32 v96, v96, v15
    v_mul_f32 v98, v98, v15
    v_mul_f32 v100, v100, v15
    v_mul_f32 v102, v102, v15
    v_mul_f32 v104, v104, v15
    v_mul_f32 v106, v106, v15
    v_mul_f32 v108, v108, v15
    v_mul_f32 v110, v110, v15
    ds_read_b64_tr_b16 v[116:117], v5 offset:0
    ds_read_b64_tr_b16 v[118:119], v5 offset:14336
    ds_read_b64_tr_b16 v[120:121], v5 offset:32
    ds_read_b64_tr_b16 v[122:123], v5 offset:14368
    ds_read_b64_tr_b16 v[124:125], v5 offset:64
    ds_read_b64_tr_b16 v[126:127], v5 offset:14400
    ds_read_b64_tr_b16 v[128:129], v5 offset:96
    ds_read_b64_tr_b16 v[130:131], v5 offset:14432
    ds_read_b64_tr_b16 v[132:133], v5 offset:128
    ds_read_b64_tr_b16 v[134:135], v5 offset:14464
    ds_read_b64_tr_b16 v[136:137], v5 offset:160
    ds_read_b64_tr_b16 v[138:139], v5 offset:14496
    ds_read_b64_tr_b16 v[140:141], v5 offset:192
    ds_read_b64_tr_b16 v[142:143], v5 offset:14528
    s_waitcnt lgkmcnt(14)
    v_mul_f32 v32, v32, v96
    v_fmac_f32 v32, v40, v98
    v_fmac_f32 v32, v48, v100
    v_fmac_f32 v32, v56, v102
    v_fmac_f32 v32, v64, v104
    v_fmac_f32 v32, v72, v106
    v_fmac_f32 v32, v80, v108
    v_fmac_f32 v32, v88, v110
    v_mul_f32 v33, v33, v96
    v_fmac_f32 v33, v41, v98
    v_fmac_f32 v33, v49, v100
    v_fmac_f32 v33, v57, v102
    v_fmac_f32 v33, v65, v104
    v_fmac_f32 v33, v73, v106
    v_fmac_f32 v33, v81, v108
    v_fmac_f32 v33, v89, v110
    v_mul_f32 v34, v34, v96
    v_fmac_f32 v34, v42, v98
    v_fmac_f32 v34, v50, v100
    v_fmac_f32 v34, v58, v102
    v_fmac_f32 v34, v66, v104
    v_fmac_f32 v34, v74, v106
    v_fmac_f32 v34, v82, v108
    v_fmac_f32 v34, v90, v110
    v_mul_f32 v35, v35, v96
    v_fmac_f32 v35, v43, v98
    v_fmac_f32 v35, v51, v100
    v_fmac_f32 v35, v59, v102
    v_fmac_f32 v35, v67, v104
    v_fmac_f32 v35, v75, v106
    v_fmac_f32 v35, v83, v108
    v_fmac_f32 v35, v91, v110
    v_mul_f32 v36, v36, v96
    v_fmac_f32 v36, v44, v98
    v_fmac_f32 v36, v52, v100
    v_fmac_f32 v36, v60, v102
    v_fmac_f32 v36, v68, v104
    v_fmac_f32 v36, v76, v106
    v_fmac_f32 v36, v84, v108
    v_fmac_f32 v36, v92, v110
    v_mul_f32 v37, v37, v96
    v_fmac_f32 v37, v45, v98
    v_fmac_f32 v37, v53, v100
    v_fmac_f32 v37, v61, v102
    v_fmac_f32 v37, v69, v104
    v_fmac_f32 v37, v77, v106
    v_fmac_f32 v37, v85, v108
    v_fmac_f32 v37, v93, v110
    v_mul_f32 v38, v38, v96
    v_fmac_f32 v38, v46, v98
    v_fmac_f32 v38, v54, v100
    v_fmac_f32 v38, v62, v102
    v_fmac_f32 v38, v70, v104
    v_fmac_f32 v38, v78, v106
    v_fmac_f32 v38, v86, v108
    v_fmac_f32 v38, v94, v110
    v_mul_f32 v39, v39, v96
    v_fmac_f32 v39, v47, v98
    v_fmac_f32 v39, v55, v100
    v_fmac_f32 v39, v63, v102
    v_fmac_f32 v39, v71, v104
    v_fmac_f32 v39, v79, v106
    v_fmac_f32 v39, v87, v108
    v_fmac_f32 v39, v95, v110
    v_cvt_pk_bf16_f32 v112, v32, v33
    v_cvt_pk_bf16_f32 v113, v34, v35
    v_cvt_pk_bf16_f32 v114, v36, v37
    v_cvt_pk_bf16_f32 v115, v38, v39
    s_branch LB_go
LB_w2:
    v_mul_u32_u24 v7, 3584, v3
    v_lshl_add_u32 v7, v4, 3, v7
    s_lshl_b32 s46, s44, 6
    s_add_u32 s46, s46, 1114112
    buffer_load_dwordx2 v[112:113], v7, s[12:15], s46 offen
    buffer_load_dwordx2 v[114:115], v7, s[12:15], s46 offen offset:32
    s_waitcnt vmcnt(0)
    s_barrier
    ds_read_b64_tr_b16 v[116:117], v5 offset:0
    ds_read_b64_tr_b16 v[118:119], v5 offset:14336
    ds_read_b64_tr_b16 v[120:121], v5 offset:32
    ds_read_b64_tr_b16 v[122:123], v5 offset:14368
    ds_read_b64_tr_b16 v[124:125], v5 offset:64
    ds_read_b64_tr_b16 v[126:127], v5 offset:14400
    ds_read_b64_tr_b16 v[128:129], v5 offset:96
    ds_read_b64_tr_b16 v[130:131], v5 offset:14432
    ds_read_b64_tr_b16 v[132:133], v5 offset:128
    ds_read_b64_tr_b16 v[134:135], v5 offset:14464
    ds_read_b64_tr_b16 v[136:137], v5 offset:160
    ds_read_b64_tr_b16 v[138:139], v5 offset:14496
    ds_read_b64_tr_b16 v[140:141], v5 offset:192
    ds_read_b64_tr_b16 v[142:143], v5 offset:14528
LB_go:
    s_waitcnt lgkmcnt(0)
    v_mfma_f32_16x16x32_bf16 v[144:147], v[116:119], v[112:115], 0
    v_mfma_f32_16x16x32_bf16 v[148:151], v[120:123], v[112:115], 0
    v_mfma_f32_16x16x32_bf16 v[152:155], v[124:127], v[112:115], 0
    v_mfma_f32_16x16x32_bf16 v[156:159], v[128:131], v[112:115], 0
    v_mfma_f32_16x16x32_bf16 v[160:163], v[132:135], v[112:115], 0
    v_mfma_f32_16x16x32_bf16 v[164:167], v[136:139], v[112:115], 0
    v_mfma_f32_16x16x32_bf16 v[168:171], v[140:143], v[112:115], 0
    s_mul_i32 s46, s2, 14336
    s_add_u32 s46, s46, 2097152
    s_add_u32 s47, s46, 3584
    v_cmp_gt_u32 vcc, 8, v3
    s_and_saveexec_b64 s[76:77], vcc
    s_nop 7
    buffer_store_dwordx4 v[144:147], v6, s[12:15], s46 offen offset:0
    buffer_store_dwordx4 v[148:151], v6, s[12:15], s46 offen offset:64
    buffer_store_dwordx4 v[152:155], v6, s[12:15], s46 offen offset:128
    buffer_store_dwordx4 v[156:159], v6, s[12:15], s46 offen offset:192
    buffer_store_dwordx4 v[160:163], v6, s[12:15], s46 offen offset:256
    buffer_store_dwordx4 v[164:167], v6, s[12:15], s46 offen offset:320
    buffer_store_dwordx4 v[168:171], v6, s[12:15], s46 offen offset:384
LB_done:
    s_endpgm
    .p2align 8
fin_kernel:
    s_cmp_ge_u32 s2, 56
    s_cbranch_scc1 LC_done
    s_load_dwordx2 s[36:37], s[0:1], 0
    s_load_dwordx4 s[40:43], s[0:1], 72
    s_load_dwordx2 s[38:39], s[0:1], 96
    v_lshrrev_b32 v2, 6, v0
    v_and_b32 v1, 63, v0
    s_nop 0
    v_readfirstlane_b32 s3, v2
    s_mul_i32 s58, s2, 9363
    s_lshr_b32 s58, s58, 16
    s_mul_i32 s59, s58, 7
    s_sub_u32 s59, s2, s59
    v_and_b32 v3, 15, v1
    v_lshrrev_b32 v4, 4, v1
    v_mul_u32_u24 v5, 14336, v4
    v_lshl_add_u32 v5, v3, 4, v5
    v_mov_b32 v6, 0x40000000
    v_cmp_gt_u32 vcc, 2, v4
    s_nop 1
    v_cndmask_b32 v6, v6, v5, vcc
    s_mul_i32 s60, s58, 1792
    s_lshl_b32 s61, s59, 8
    s_add_u32 s60, s60, s61
    s_add_u32 s60, s60, 2097152
    s_mul_i32 s61, s3, 458752
    s_add_u32 s61, s61, s60
    s_mul_i32 s62, s3, 200704
    s_add_u32 s62, s62, s60
    s_add_u32 s62, s62, 1835008
    s_waitcnt lgkmcnt(0)
    s_mov_b32 s8, s38
    s_mov_b32 s9, s39
    s_mov_b32 s10, 6291456
    s_mov_b32 s11, 0x20000
    s_mov_b32 s12, s36
    s_mov_b32 s13, s37
    s_mov_b32 s14, 7168
    s_mov_b32 s15, 0x20000
    s_mov_b32 s16, s40
    s_mov_b32 s17, s41
    s_mov_b32 s18, 896
    s_mov_b32 s19, 0x20000
    s_mov_b32 s20, s42
    s_mov_b32 s21, s43
    s_mov_b32 s22, 7168
    s_mov_b32 s23, 0x20000
    buffer_load_dwordx4 v[32:35], v5, s[8:11], s61 offen
    s_add_u32 s61, s61, 57344
    buffer_load_dwordx4 v[36:39], v5, s[8:11], s61 offen
    s_add_u32 s61, s61, 57344
    buffer_load_dwordx4 v[40:43], v5, s[8:11], s61 offen
    s_add_u32 s61, s61, 57344
    buffer_load_dwordx4 v[44:47], v5, s[8:11], s61 offen
    s_add_u32 s61, s61, 57344
    buffer_load_dwordx4 v[48:51], v5, s[8:11], s61 offen
    s_add_u32 s61, s61, 57344
    buffer_load_dwordx4 v[52:55], v5, s[8:11], s61 offen
    s_add_u32 s61, s61, 57344
    buffer_load_dwordx4 v[56:59], v5, s[8:11], s61 offen
    s_add_u32 s61, s61, 57344
    buffer_load_dwordx4 v[60:63], v5, s[8:11], s61 offen
    s_add_u32 s61, s61, 57344
    buffer_load_dwordx4 v[64:67], v5, s[8:11], s62 offen
    s_add_u32 s62, s62, 57344
    buffer_load_dwordx4 v[68:71], v5, s[8:11], s62 offen
    s_add_u32 s62, s62, 57344
    buffer_load_dwordx4 v[72:75], v5, s[8:11], s62 offen
    s_add_u32 s62, s62, 57344
    buffer_load_dwordx4 v[76:79], v6, s[8:11], s62 offen
    s_add_u32 s62, s62, 57344
    v_lshlrev_b32 v7, 1, v1
    s_lshl_b32 s63, s59, 7
    s_mul_i32 s64, s58, 896
    s_add_u32 s64, s64, s63
    buffer_load_ushort v8, v7, s[12:15], s64 offen
    buffer_load_ushort v9, v7, s[16:19], s63 offen
    s_waitcnt vmcnt(6)
    v_add_f32 v32, v32, v48
    v_add_f32 v33, v33, v49
    v_add_f32 v34, v34, v50
    v_add_f32 v35, v35, v51
    v_add_f32 v36, v36, v52
    v_add_f32 v37, v37, v53
    v_add_f32 v38, v38, v54
    v_add_f32 v39, v39, v55
    v_add_f32 v40, v40, v56
    v_add_f32 v41, v41, v57
    v_add_f32 v42, v42, v58
    v_add_f32 v43, v43, v59
    v_add_f32 v44, v44, v60
    v_add_f32 v45, v45, v61
    v_add_f32 v46, v46, v62
    v_add_f32 v47, v47, v63
    v_add_f32 v32, v32, v40
    v_add_f32 v33, v33, v41
    v_add_f32 v34, v34, v42
    v_add_f32 v35, v35, v43
    v_add_f32 v36, v36, v44
    v_add_f32 v37, v37, v45
    v_add_f32 v38, v38, v46
    v_add_f32 v39, v39, v47
    v_add_f32 v32, v32, v36
    v_add_f32 v33, v33, v37
    v_add_f32 v34, v34, v38
    v_add_f32 v35, v35, v39
    s_waitcnt vmcnt(2)
    v_add_f32 v64, v64, v72
    v_add_f32 v65, v65, v73
    v_add_f32 v66, v66, v74
    v_add_f32 v67, v67, v75
    v_add_f32 v68, v68, v76
    v_add_f32 v69, v69, v77
    v_add_f32 v70, v70, v78
    v_add_f32 v71, v71, v79
    v_add_f32 v64, v64, v68
    v_add_f32 v65, v65, v69
    v_add_f32 v66, v66, v70
    v_add_f32 v67, v67, v71
    v_mov_b32 v10, v32
    s_nop 1
    v_permlane16_swap_b32 v32, v10
    v_add_f32 v32, v32, v10
    v_mov_b32 v10, v32
    s_nop 1
    v_permlane32_swap_b32 v32, v10
    v_add_f32 v32, v32, v10
    v_mov_b32 v10, v64
    s_nop 1
    v_permlane16_swap_b32 v64, v10
    v_add_f32 v64, v64, v10
    v_mov_b32 v10, v64
    s_nop 1
    v_permlane32_swap_b32 v64, v10
    v_add_f32 v64, v64, v10
    v_mov_b32 v10, v33
    s_nop 1
    v_permlane16_swap_b32 v33, v10
    v_add_f32 v33, v33, v10
    v_mov_b32 v10, v33
    s_nop 1
    v_permlane32_swap_b32 v33, v10
    v_add_f32 v33, v33, v10
    v_mov_b32 v10, v65
    s_nop 1
    v_permlane16_swap_b32 v65, v10
    v_add_f32 v65, v65, v10
    v_mov_b32 v10, v65
    s_nop 1
    v_permlane32_swap_b32 v65, v10
    v_add_f32 v65, v65, v10
    v_mov_b32 v10, v34
    s_nop 1
    v_permlane16_swap_b32 v34, v10
    v_add_f32 v34, v34, v10
    v_mov_b32 v10, v34
    s_nop 1
    v_permlane32_swap_b32 v34, v10
    v_add_f32 v34, v34, v10
    v_mov_b32 v10, v66
    s_nop 1
    v_permlane16_swap_b32 v66, v10
    v_add_f32 v66, v66, v10
    v_mov_b32 v10, v66
    s_nop 1
    v_permlane32_swap_b32 v66, v10
    v_add_f32 v66, v66, v10
    v_mov_b32 v10, v35
    s_nop 1
    v_permlane16_swap_b32 v35, v10
    v_add_f32 v35, v35, v10
    v_mov_b32 v10, v35
    s_nop 1
    v_permlane32_swap_b32 v35, v10
    v_add_f32 v35, v35, v10
    v_mov_b32 v10, v67
    s_nop 1
    v_permlane16_swap_b32 v67, v10
    v_add_f32 v67, v67, v10
    v_mov_b32 v10, v67
    s_nop 1
    v_permlane32_swap_b32 v67, v10
    v_add_f32 v67, v67, v10
    s_lshl_b32 s65, s3, 9
    v_lshlrev_b32 v10, 4, v3
    v_add_u32 v10, s65, v10
    v_cmp_gt_u32 vcc, 16, v1
    s_and_saveexec_b64 s[76:77], vcc
    ds_write_b128 v10, v[32:35]
    ds_write_b128 v10, v[64:67] offset:256
    s_mov_b64 exec, s[76:77]
    s_waitcnt lgkmcnt(0)
    s_barrier
    s_cmp_lg_u32 s3, 0
    s_cbranch_scc1 LC_done
    v_lshlrev_b32 v10, 2, v1
    ds_read_b32 v16, v10 offset:0
    ds_read_b32 v20, v10 offset:256
    ds_read_b32 v17, v10 offset:512
    ds_read_b32 v21, v10 offset:768
    ds_read_b32 v18, v10 offset:1024
    ds_read_b32 v22, v10 offset:1280
    ds_read_b32 v19, v10 offset:1536
    ds_read_b32 v23, v10 offset:1792
    s_waitcnt lgkmcnt(0)
    v_add_f32 v16, v16, v17
    v_add_f32 v18, v18, v19
    v_add_f32 v16, v16, v18
    v_add_f32 v20, v20, v21
    v_add_f32 v22, v22, v23
    v_add_f32 v20, v20, v22
    s_waitcnt vmcnt(0)
    v_cvt_pk_bf16_f32 v16, v16, v16
    v_lshlrev_b32 v16, 16, v16
    v_cvt_pk_bf16_f32 v20, v20, v20
    v_lshlrev_b32 v20, 16, v20
    v_lshlrev_b32 v9, 16, v9
    v_lshlrev_b32 v8, 16, v8
    v_add_f32 v20, v20, v9
    v_cvt_pk_bf16_f32 v20, v20, v20
    v_lshlrev_b32 v20, 16, v20
    v_mul_f32 v21, 0xbfb8aa3b, v20
    v_exp_f32 v21, v21
    s_nop 0
    v_add_f32 v21, 1.0, v21
    v_rcp_f32 v21, v21
    s_nop 0
    v_mul_f32 v20, v20, v21
    v_cvt_pk_bf16_f32 v20, v20, v20
    v_lshlrev_b32 v20, 16, v20
    v_mul_f32 v16, v16, v20
    v_cvt_pk_bf16_f32 v16, v16, v16
    v_lshlrev_b32 v16, 16, v16
    v_add_f32 v16, v16, v8
    v_cvt_pk_bf16_f32 v16, v16, v16
    buffer_store_short v16, v7, s[20:23], s64 offen
LC_done:
    s_endpgm
.section .rodata,"a"
.p2align 6
.amdhsa_kernel recurrent_scan__gqa_block_cached__dense_activation_gelu__decode_kernel
  .amdhsa_next_free_vgpr 384
  .amdhsa_next_free_sgpr 96
  .amdhsa_accum_offset 256
  .amdhsa_group_segment_fixed_size 0
  .amdhsa_kernarg_size 104
  .amdhsa_user_sgpr_count 2
  .amdhsa_user_sgpr_kernarg_segment_ptr 1
  .amdhsa_system_sgpr_workgroup_id_x 1
.end_amdhsa_kernel
.p2align 6
.amdhsa_kernel proj_kernel
  .amdhsa_next_free_vgpr 176
  .amdhsa_next_free_sgpr 96
  .amdhsa_accum_offset 176
  .amdhsa_group_segment_fixed_size 0
  .amdhsa_kernarg_size 104
  .amdhsa_user_sgpr_count 2
  .amdhsa_user_sgpr_kernarg_segment_ptr 1
  .amdhsa_system_sgpr_workgroup_id_x 1
.end_amdhsa_kernel
.p2align 6
.amdhsa_kernel fin_kernel
  .amdhsa_next_free_vgpr 80
  .amdhsa_next_free_sgpr 96
  .amdhsa_accum_offset 80
  .amdhsa_group_segment_fixed_size 0
  .amdhsa_kernarg_size 104
  .amdhsa_user_sgpr_count 2
  .amdhsa_user_sgpr_kernarg_segment_ptr 1
  .amdhsa_system_sgpr_workgroup_id_x 1
.end_amdhsa_kernel
```
